```python
import torch

def _softmax(x, axis=-1):
    return torch.softmax(x, dim=axis)
def _gelu(x):
    return torch.nn.functional.gelu(x, approximate="tanh")
def _silu(x):
    return torch.nn.functional.silu(x)
def _sigmoid(x):
    return torch.sigmoid(x)
def _layernorm(x, axis=-1, eps=1e-5):
    m = x.mean(dim=axis, keepdim=True)
    v = x.var(dim=axis, keepdim=True, unbiased=False)
    return (x - m) / torch.sqrt(v + eps)
def _scatter_add(tgt, idx, src, axis=0):
    return tgt.clone().index_add_(axis, idx, src)
def _segment_sum(src, seg, n):
    out = torch.zeros((n,) + src.shape[1:], dtype=src.dtype)
    return out.index_add_(0, seg, src)
def _pad(x, pw):
    flat = tuple(v for pair in reversed(pw) for v in pair)
    return torch.nn.functional.pad(x, flat)

kernel_name = 'gated_mix__gqa_block_cached__glu_gated_glu__decode'

def setup_inputs():

    _w = (lambda a: (lambda t: t.to(torch.bfloat16) if t.is_floating_point() else t)(torch.as_tensor(a)))
    def _A_setup():
        B, Sq, D = 2, 1, 448
        Hq, Hkv, Sk, Dh = 16, 8, 16384, 256
        assert Hq % Hkv == 0, (Hq, Hkv)
        return {
            "x": _w((lambda *s: torch.randn(*s, dtype=torch.bfloat16) * 0.05)(B, Sq, D)),
            "k_cache": _w((lambda *s: torch.randn(*s, dtype=torch.bfloat16) * 6.4)(B, Hkv, Sk, Dh)),
            "v_cache": _w((lambda *s: torch.randn(*s, dtype=torch.bfloat16) * 0.4)(B, Hkv, Sk, Dh)),
            "wq": _w((lambda *s: torch.randn(*s, dtype=torch.bfloat16) * 6.4)(D, Hq * Dh) * (D ** -0.5)),
            "wo": _w((lambda *s: torch.randn(*s, dtype=torch.bfloat16) * 0.4)(Hq * Dh, D) * ((Hq * Dh) ** -0.5)),
        }
    _A_in = _A_setup()

    def _B_setup():
        B, S, D, F = 2, 1, 448, 1792
        return {
            "x": _w((lambda *s: torch.randn(*s, dtype=torch.bfloat16) * 0.05)(B, S, D)),
            "w_gate": _w((lambda *s: torch.randn(*s, dtype=torch.bfloat16) * 0.4)(D, F)),
            "w_up": _w((lambda *s: torch.randn(*s, dtype=torch.bfloat16) * 0.05)(D, F)),
            "w_down": _w((lambda *s: torch.randn(*s, dtype=torch.bfloat16) * 0.05)(F, D)),
        }
    _B_in = _B_setup()

    return {
        "A_x": _A_in["x"],
        "A_k_cache": _A_in["k_cache"],
        "A_v_cache": _A_in["v_cache"],
        "A_wq": _A_in["wq"],
        "A_wo": _A_in["wo"],
        "B_x": _B_in["x"],
        "B_w_gate": _B_in["w_gate"],
        "B_w_up": _B_in["w_up"],
        "B_w_down": _B_in["w_down"],
        "gate_w": _w((lambda *s: torch.randn(*s, dtype=torch.bfloat16) * 0.05)(448) * 16.0),
    }

def reference(A_x, A_k_cache, A_v_cache, A_wq, A_wo, B_x, B_w_gate, B_w_up, B_w_down, gate_w):
    def _A_ref(x, k_cache, v_cache, wq, wo):
        B, Sq, D = x.shape
        Hq, Dh = 16, 256
        Hkv = k_cache.shape[1]
        rep = Hq // Hkv
        q = (lambda x, *d: x.permute(*d))((x @ wq).reshape(B, Sq, Hq, Dh), 0, 2, 1, 3)
        k = (lambda x, n, axis: torch.repeat_interleave(x, n, dim=axis))(k_cache, rep, axis=1)
        v = (lambda x, n, axis: torch.repeat_interleave(x, n, dim=axis))(v_cache, rep, axis=1)
        scores = torch.einsum("bhqd,bhkd->bhqk", q, k) * (Dh ** -0.5)
        p = _softmax(scores, axis=-1)
        o = torch.einsum("bhqk,bhkd->bhqd", p, v)
        return (lambda x, *d: x.permute(*d))(o, 0, 2, 1, 3).reshape(B, Sq, Hq * Dh) @ wo

    def _B_ref(x, w_gate, w_up, w_down):
        g = torch.einsum("bsd,df->bsf", x, w_gate)
        u = torch.einsum("bsd,df->bsf", x, w_up)
        h = _sigmoid(g) * u
        return torch.einsum("bsf,fd->bsd", h, w_down)

    x = A_x
    g = _sigmoid((x * gate_w).sum(-1, keepdims=True))
    a = _A_ref(x, A_k_cache, A_v_cache, A_wq, A_wo)
    b = _B_ref(x, B_w_gate, B_w_up, B_w_down)
    return g * a + (1 - g) * b
```

```asm
; @launch grid=(256,1,1) block=(320,1,1) lds=59392
.amdgcn_target "amdgcn-amd-amdhsa--gfx950"
.text
.globl gated_mix__gqa_block_cached__glu_gated_glu__decode_kernel
.p2align 12
.fill 832, 4, 0xbf810000
.p2align 8
.type gated_mix__gqa_block_cached__glu_gated_glu__decode_kernel,@function
gated_mix__gqa_block_cached__glu_gated_glu__decode_kernel:
    s_cmp_ge_u32 s2, 256
    s_cbranch_scc1 L_end
    s_load_dwordx16 s[4:19], s[0:1], 0
    s_load_dwordx8 s[20:27], s[0:1], 64
    s_load_dwordx2 s[28:29], s[0:1], 96
    v_lshrrev_b32 v1, 6, v0
    v_and_b32 v0, 63, v0
    v_readfirstlane_b32 s3, v1
    v_lshrrev_b32 v2, 4, v0
    v_and_b32 v3, 15, v0
    s_mov_b32 s35, 0x20000
    s_mov_b32 s39, 0x20000
    s_mov_b32 s43, 0x20000
    s_mov_b32 s42, 8388608
    s_and_b32 s30, s2, 7
    s_lshr_b32 s31, s2, 7
    s_lshl_b32 s66, s31, 4
    s_lshl_b32 s31, s31, 1
    s_bfe_u32 s64, s2, 0x10003
    s_add_u32 s31, s31, s64
    s_and_b32 s64, s2, 15
    s_add_u32 s66, s66, s64
    s_bfe_u32 s64, s2, 0x30004
    s_lshl_b32 s65, s64, 3
    s_add_u32 s65, s65, s30
    s_cmp_eq_u32 s3, 0
    s_cbranch_scc0 L_stream
    v_mov_b32 v1, 0
    v_lshlrev_b32 v4, 2, v3
    v_lshrrev_b32 v13, 3, v0
    ds_write_b32 v4, v1 offset:17408
    v_and_b32 v12, 6, v13
    v_xor_b32 v12, v12, v0
    v_and_b32 v12, 7, v12
    v_lshlrev_b32 v12, 4, v12
    v_lshl_add_u32 v4, v13, 13, v12
    v_lshlrev_b32 v5, 4, v0
    v_and_b32 v107, 31, v0
    v_lshlrev_b32 v107, 5, v107
    s_mul_i32 s48, s31, 917504
    s_lshl_b32 s44, s65, 7
    s_add_u32 s48, s48, s44
    s_mov_b32 s34, 1792
    s_mov_b32 s38, 3670016
    s_mov_b32 s70, 896
    s_mov_b32 s71, 0x20000
    s_mov_b32 m0, 0
    s_waitcnt lgkmcnt(0)
    s_mov_b32 s36, s10
    s_mov_b32 s37, s11
    s_mov_b32 s32, s4
    s_mov_b32 s33, s5
    s_mov_b32 s68, s22
    s_mov_b32 s69, s23
    buffer_load_dwordx4 v5, s[32:35], 0 offen lds
    buffer_load_dwordx4 v5, s[32:35], 0 offen offset:1024 lds
    s_mov_b32 m0, 2048
    s_nop 0
L_qdma:
    buffer_load_dwordx4 v4, s[36:39], s48 offen nt lds
    s_add_u32 m0, m0, 1024
    s_add_u32 s48, s48, 65536
    s_cmp_lt_u32 m0, 16384
    s_cbranch_scc1 L_qdma
    buffer_load_dwordx4 v[108:111], v107, s[68:71], 0 offen
    buffer_load_dwordx4 v[112:115], v107, s[68:71], 0 offen offset:16
    s_barrier
    s_load_dword s46, s[28:29], 0
    s_mov_b32 s40, s28
    s_mov_b32 s41, s29
    s_branch L_helper
L_stream:
    v_and_b32 v6, 3, v3
    v_lshlrev_b32 v208, 6, v2
    v_lshl_add_u32 v208, v6, 4, v208
    s_sub_u32 s44, s3, 1
    s_lshr_b32 s49, s2, 4
    s_lshl_b32 s47, s49, 23
    s_mov_b32 s34, 0x8000000
    v_bfe_i32 v1, v3, 2, 1
    v_and_b32 v1, 0x19200, v1
    v_xor_b32 v208, v208, v1
    v_bfe_i32 v1, v3, 3, 1
    v_and_b32 v1, 0x103200, v1
    v_xor_b32 v208, v208, v1
    s_bitcmp1_b32 s49, 0
    s_cselect_b32 s48, 0xe7200, 0
    s_xor_b32 s47, s47, s48
    s_bitcmp1_b32 s49, 1
    s_cselect_b32 s48, 0x641400, 0
    s_xor_b32 s47, s47, s48
    s_bitcmp1_b32 s49, 2
    s_cselect_b32 s48, 0x28ba00, 0
    s_xor_b32 s47, s47, s48
    s_bitcmp1_b32 s49, 3
    s_cselect_b32 s48, 0x28d800, 0
    s_xor_b32 s47, s47, s48
    s_bitcmp1_b32 s2, 0
    s_cselect_b32 s48, 0xa000, 0
    s_xor_b32 s45, s47, s48
    s_bitcmp1_b32 s2, 1
    s_cselect_b32 s48, 0x5000, 0
    s_xor_b32 s45, s45, s48
    s_bitcmp1_b32 s2, 2
    s_cselect_b32 s48, 0x1200, 0
    s_xor_b32 s45, s45, s48
    s_bitcmp1_b32 s2, 3
    s_cselect_b32 s48, 0x88800, 0
    s_xor_b32 s45, s45, s48
    s_bitcmp1_b32 s44, 0
    s_cselect_b32 s48, 0x1000, 0
    s_xor_b32 s45, s45, s48
    s_bitcmp1_b32 s44, 1
    s_cselect_b32 s48, 0x20c000, 0
    s_xor_b32 s45, s45, s48
    s_xor_b32 s96, s45, 0x80800
    s_xor_b32 s97, s45, 0x4400
    s_xor_b32 s98, s96, 0x4400
    s_cmp_eq_u32 s3, 1
    s_cbranch_scc1 L_tch1
    s_cmp_eq_u32 s3, 2
    s_cbranch_scc1 L_tch2
    s_cmp_eq_u32 s3, 3
    s_cbranch_scc1 L_tch3
    s_branch L_tch4
L_tback:
    s_waitcnt lgkmcnt(0)
    s_mov_b32 s32, s6
    s_mov_b32 s33, s7
    s_barrier
    v_xor_b32 v209, s45, v208
    buffer_load_dwordx4 v[64:67], v209, s[32:35], 0 offen offset:0 nt
    buffer_load_dwordx4 v[68:71], v209, s[32:35], 0 offen offset:256 nt
    v_xor_b32 v209, s96, v208
    buffer_load_dwordx4 v[72:75], v209, s[32:35], 0 offen offset:0 nt
    buffer_load_dwordx4 v[76:79], v209, s[32:35], 0 offen offset:256 nt
    v_xor_b32 v209, s97, v208
    buffer_load_dwordx4 v[80:83], v209, s[32:35], 0 offen offset:0 nt
    buffer_load_dwordx4 v[84:87], v209, s[32:35], 0 offen offset:256 nt
    s_mov_b32 s38, s45
    s_load_dword s67, s[28:29], 0
    s_mov_b32 s36, s8
    s_mov_b32 s37, s9
    s_mov_b32 s40, s28
    s_mov_b32 s41, s29
    s_lshr_b32 s58, s2, 4
    s_lshl_b32 s48, s58, 2
    s_lshr_b32 s27, s2, 1
    s_add_u32 s27, s44, s27
    s_and_b32 s27, s27, 3
    s_add_u32 s48, s48, s27
    s_lshl_b32 s58, s48, 12
    s_add_u32 s58, s58, 1048576
    s_mul_i32 s48, s48, 512
    s_add_u32 s48, s48, 458752
    s_add_u32 s50, s28, s48
    s_addc_u32 s51, s29, 0
    s_mov_b32 s46, 0
    s_mov_b32 s52, 0x3db8aa3b
    s_mov_b32 s53, 0
    s_mov_b32 s57, 0
    s_mov_b32 s4, s12
    s_mov_b32 s5, s13
    s_mov_b32 s6, 3670016
    s_mov_b32 s7, 0x20000
    s_mov_b32 s8, s20
    s_mov_b32 s9, s21
    s_mov_b32 s10, 1605632
    s_mov_b32 s11, 0x20000
    s_bitcmp1_b32 s27, 0
    s_cselect_b32 s48, 0x5000, 0
    s_xor_b32 s47, s47, s48
    s_bitcmp1_b32 s27, 1
    s_cselect_b32 s48, 0x1200, 0
    s_xor_b32 s47, s47, s48
    s_mov_b32 s76, 0x80800
    s_mov_b32 s77, 0x4400
    s_mov_b32 s81, 0x489000
    s_mov_b32 s82, 0x81000
    s_mov_b32 s83, 0xc9000
    s_mov_b32 s84, 0x4e2600
    s_mov_b32 s78, 0x1000
    s_mov_b32 s79, 0x20c000
    s_mov_b32 s80, 0x88800
    s_mov_b32 s85, 0xa000
    s_lshr_b32 s15, s2, 3
    s_min_u32 s15, s15, 27
    s_mul_i32 s14, s15, 37
    s_lshr_b32 s14, s14, 8
    s_mul_i32 s48, s14, 7
    s_sub_u32 s15, s15, s48
    s_and_b32 s48, s2, 7
    s_lshl_b32 s48, s48, 2
    s_add_u32 s14, s14, s48
    s_mul_i32 s12, s14, 114688
    s_lshl_b32 s48, s15, 7
    s_add_u32 s12, s12, s48
    s_mul_i32 s13, s14, 50176
    s_add_u32 s13, s13, s48
    v_lshrrev_b32 v1, 3, v0
    v_and_b32 v6, 6, v1
    v_xor_b32 v6, v6, v0
    v_and_b32 v6, 7, v6
    v_lshlrev_b32 v6, 4, v6
    v_mul_u32_u24 v193, 896, v1
    v_add_u32 v193, v193, v6
    v_lshrrev_b32 v7, 5, v0
    v_mul_u32_u24 v7, 3584, v7
    v_add_u32 v192, v193, v7
    v_and_b32 v6, 1, v3
    v_cmp_eq_u32 vcc, 1, v6
    v_mov_b32 v7, 0xffff
    v_mov_b32 v48, 0xffff0000
    v_cndmask_b32 v7, v7, v48, vcc
    v_bfe_u32 v6, v3, 1, 2
    v_cmp_eq_u32 vcc, 0, v6
    v_mov_b32 v20, 0
    v_mov_b32 v21, 0
    v_cndmask_b32 v16, 0, v7, vcc
    v_cmp_eq_u32 vcc, 1, v6
    v_mov_b32 v22, 0
    v_mov_b32 v23, 0
    v_cndmask_b32 v17, 0, v7, vcc
    v_cmp_eq_u32 vcc, 2, v6
    v_mov_b32 v24, 0
    v_mov_b32 v25, 0
    v_cndmask_b32 v18, 0, v7, vcc
    v_cmp_eq_u32 vcc, 3, v6
    v_mov_b32 v26, 0
    v_mov_b32 v27, 0
    v_cndmask_b32 v19, 0, v7, vcc
    v_mov_b32 v28, 0xff7fffff
    v_mov_b32 v6, 0
    v_lshrrev_b32 v1, 3, v3
    v_lshlrev_b32 v194, 9, v1
    v_lshl_add_u32 v194, v2, 6, v194
    v_and_b32 v48, 3, v3
    v_lshl_add_u32 v194, v48, 4, v194
    v_lshlrev_b32 v195, 4, v0
    v_and_b32 v30, 0x38, v0
    s_lshl_b32 s48, s44, 6
    v_add_u32 v7, s48, v30
    v_lshrrev_b32 v50, 1, v2
    v_and_b32 v48, 1, v2
    v_and_b32 v49, 7, v3
    v_lshlrev_b32 v196, 15, v50
    v_lshl_add_u32 v196, v48, 8, v196
    v_lshl_add_u32 v196, v3, 4, v196
    s_lshl_b32 s16, s64, 16
    s_lshl_b32 s48, s66, 9
    s_add_u32 s16, s16, s48
    s_add_u32 s16, s16, 524288
    s_add_u32 s26, s16, 0x4000
    v_lshrrev_b32 v197, 3, v0
    v_lshlrev_b32 v197, 9, v197
    v_lshl_add_u32 v197, v49, 4, v197
    s_lshl_b32 s17, s14, 14
    s_lshl_b32 s48, s44, 7
    s_add_u32 s17, s17, s48
    s_add_u32 s17, s17, 524288
    s_add_u32 s66, s17, 0x1000
    s_add_u32 s65, s17, 0x2000
    s_add_u32 s31, s17, 0x3000
    v_lshlrev_b32 v198, 7, v1
    v_lshl_add_u32 v198, v2, 3, v198
    v_lshlrev_b32 v199, 3, v50
    v_lshlrev_b32 v200, 8, v50
    v_lshl_add_u32 v200, v48, 2, v200
    v_and_b32 v4, 3, v0
    v_lshl_add_u32 v200, v4, 4, v200
    v_bfe_u32 v4, v0, 2, 1
    v_lshl_add_u32 v200, v4, 3, v200
    s_lshl_b32 s48, s44, 6
    v_add_u32 v200, s48, v200
    v_lshlrev_b32 v201, 8, v1
    v_lshl_add_u32 v201, v2, 4, v201
    v_mul_u32_u24 v203, 896, v50
    v_lshl_add_u32 v203, v3, 1, v203
    s_mov_b32 s60, 0x00800100
    s_mov_b32 s61, 0x00800100
    v_lshl_add_u32 v202, v50, 3, v48
    v_mul_u32_u24 v202, 128, v202
    v_cndmask_b32 v4, v49, 8, s[60:61]
    v_lshl_add_u32 v202, v4, 2, v202
    v_lshlrev_b32 v204, 2, v1
    v_mov_b32 v205, 0xffffff00
    v_mov_b32 v206, 1
    v_mul_u32_u24 v207, 512, v0
    v_lshrrev_b32 v4, 2, v0
    v_lshlrev_b32 v5, 7, v4
    v_and_b32 v48, 3, v0
    v_lshl_add_u32 v5, v48, 3, v5
    v_bfe_u32 v4, v4, 1, 2
    v_xor_b32 v4, s44, v4
    v_lshl_add_u32 v5, v4, 5, v5
    s_lshl_b32 s18, s15, 3
    s_add_u32 s18, s18, s44
    s_mul_i32 s18, s18, 256
    s_add_u32 s18, s18, 327680
    s_lshl_b32 s19, s15, 7
    s_lshl_b32 s48, s44, 5
    s_add_u32 s19, s19, s48
    s_mov_b32 s20, s24
    s_mov_b32 s21, s25
    s_mov_b32 s22, 1792
    s_mov_b32 s23, 0x20000
    s_mul_i32 s48, s14, 512
    s_xor_b32 s48, s48, 459008
    s_add_u32 s24, s28, s48
    s_addc_u32 s25, s29, 0
    s_mul_i32 s30, s64, 2048
    s_xor_b32 s30, s30, 459008
    s_branch L_pro1
L_tch3:
    s_branch L_tback
L_pro1:
    v_xor_b32 v209, s98, v208
    s_waitcnt vmcnt(4)
    buffer_load_dwordx4 v[88:91], v209, s[32:35], 0 offen offset:0 nt
    s_waitcnt vmcnt(4)
    buffer_load_dwordx4 v[92:95], v209, s[32:35], 0 offen offset:256 nt
    s_xor_b32 s45, s38, s81
    s_xor_b32 s96, s45, s76
    s_xor_b32 s97, s45, s77
    s_xor_b32 s98, s96, s77
    v_xor_b32 v209, s45, v208
    s_waitcnt vmcnt(4)
    buffer_load_dwordx4 v[96:99], v209, s[32:35], 0 offen offset:0 nt
    buffer_load_dwordx4 v[100:103], v209, s[32:35], 0 offen offset:256 nt
    v_xor_b32 v209, s96, v208
    s_waitcnt vmcnt(4)
    buffer_load_dwordx4 v[104:107], v209, s[32:35], 0 offen offset:0 nt
    s_waitcnt vmcnt(4)
    buffer_load_dwordx4 v[108:111], v209, s[32:35], 0 offen offset:256 nt
    v_xor_b32 v209, s97, v208
    s_waitcnt vmcnt(4)
    buffer_load_dwordx4 v[112:115], v209, s[32:35], 0 offen offset:0 nt
    buffer_load_dwordx4 v[116:119], v209, s[32:35], 0 offen offset:256 nt
    v_xor_b32 v209, s98, v208
    s_waitcnt vmcnt(4)
    buffer_load_dwordx4 v[120:123], v209, s[32:35], 0 offen offset:0 nt
    s_waitcnt vmcnt(4)
    buffer_load_dwordx4 v[124:127], v209, s[32:35], 0 offen offset:256 nt
    s_xor_b32 s45, s38, s82
    s_xor_b32 s96, s45, s76
    s_xor_b32 s97, s45, s77
    s_xor_b32 s98, s96, s77
    v_xor_b32 v209, s45, v208
    s_waitcnt vmcnt(4)
    buffer_load_dwordx4 v[128:131], v209, s[32:35], 0 offen offset:0 nt
    buffer_load_dwordx4 v[132:135], v209, s[32:35], 0 offen offset:256 nt
    v_xor_b32 v209, s96, v208
    s_waitcnt vmcnt(4)
    buffer_load_dwordx4 v[136:139], v209, s[32:35], 0 offen offset:0 nt
    s_waitcnt vmcnt(4)
    buffer_load_dwordx4 v[140:143], v209, s[32:35], 0 offen offset:256 nt
    v_xor_b32 v209, s97, v208
    s_waitcnt vmcnt(4)
    buffer_load_dwordx4 v[144:147], v209, s[32:35], 0 offen offset:0 nt
    buffer_load_dwordx4 v[148:151], v209, s[32:35], 0 offen offset:256 nt
    v_xor_b32 v209, s98, v208
    s_waitcnt vmcnt(4)
    buffer_load_dwordx4 v[152:155], v209, s[32:35], 0 offen offset:0 nt
    s_waitcnt vmcnt(4)
    buffer_load_dwordx4 v[156:159], v209, s[32:35], 0 offen offset:256 nt
    s_xor_b32 s45, s38, s81
    s_xor_b32 s45, s45, s82
    s_xor_b32 s96, s45, s76
    s_xor_b32 s97, s45, s77
    s_xor_b32 s98, s96, s77
    v_xor_b32 v209, s45, v208
    s_waitcnt vmcnt(4)
    buffer_load_dwordx4 v[160:163], v209, s[32:35], 0 offen offset:0 nt
    buffer_load_dwordx4 v[164:167], v209, s[32:35], 0 offen offset:256 nt
    v_xor_b32 v209, s96, v208
    s_waitcnt vmcnt(4)
    buffer_load_dwordx4 v[168:171], v209, s[32:35], 0 offen offset:0 nt
    s_waitcnt vmcnt(4)
    buffer_load_dwordx4 v[172:175], v209, s[32:35], 0 offen offset:256 nt
    v_xor_b32 v209, s97, v208
    s_waitcnt vmcnt(4)
    buffer_load_dwordx4 v[176:179], v209, s[32:35], 0 offen offset:0 nt
    buffer_load_dwordx4 v[180:183], v209, s[32:35], 0 offen offset:256 nt
    v_xor_b32 v209, s98, v208
    s_waitcnt vmcnt(4)
    buffer_load_dwordx4 v[184:187], v209, s[32:35], 0 offen offset:0 nt
    s_waitcnt vmcnt(4)
    buffer_load_dwordx4 v[188:191], v209, s[32:35], 0 offen offset:256 nt
    s_mov_b32 s59, 3200000
L_qw:
    ds_read_b32 v48, v6 offset:17408
    s_sub_u32 s59, s59, 1
    s_cbranch_scc1 L_qwx
    s_waitcnt lgkmcnt(0)
    v_cmp_gt_u32 vcc, 1, v48
    s_cbranch_vccnz L_qw
L_qwx:
    ds_read_b128 v[8:11], v194 offset:16384
    ds_read_b128 v[12:15], v194 offset:16640
    s_add_u32 s67, s67, 0x01010101
    s_and_b32 s68, s67, 0xff
    s_bfe_u32 s69, s67, 0x80008
    s_bfe_u32 s70, s67, 0x80010
    s_lshr_b32 s71, s67, 24
    s_waitcnt lgkmcnt(0)
L_k0:
    s_cmp_eq_u32 s46, 0
    s_cbranch_scc1 L_ka0
    s_xor_b32 s45, s45, s81
    s_xor_b32 s96, s45, s76
    s_xor_b32 s97, s45, s77
    s_xor_b32 s98, s96, s77
    v_xor_b32 v209, s45, v208
    s_waitcnt vmcnt(4)
    buffer_load_dwordx4 v[96:99], v209, s[32:35], 0 offen offset:0 nt
    buffer_load_dwordx4 v[100:103], v209, s[32:35], 0 offen offset:256 nt
    v_xor_b32 v209, s96, v208
    s_waitcnt vmcnt(4)
    buffer_load_dwordx4 v[104:107], v209, s[32:35], 0 offen offset:0 nt
    s_waitcnt vmcnt(4)
    buffer_load_dwordx4 v[108:111], v209, s[32:35], 0 offen offset:256 nt
    v_xor_b32 v209, s97, v208
    s_waitcnt vmcnt(4)
    buffer_load_dwordx4 v[112:115], v209, s[32:35], 0 offen offset:0 nt
    buffer_load_dwordx4 v[116:119], v209, s[32:35], 0 offen offset:256 nt
    v_xor_b32 v209, s98, v208
    s_waitcnt vmcnt(4)
    buffer_load_dwordx4 v[120:123], v209, s[32:35], 0 offen offset:0 nt
    s_waitcnt vmcnt(4)
    buffer_load_dwordx4 v[124:127], v209, s[32:35], 0 offen offset:256 nt
L_ka0:
    v_mfma_f32_16x16x32_bf16 v[32:35], v[64:67], v[8:11], 0
    v_mfma_f32_16x16x32_bf16 v[36:39], v[72:75], v[8:11], 0
    v_mfma_f32_16x16x32_bf16 v[40:43], v[80:83], v[8:11], 0
    v_mfma_f32_16x16x32_bf16 v[44:47], v[88:91], v[8:11], 0
    v_mfma_f32_16x16x32_bf16 v[32:35], v[68:71], v[12:15], v[32:35]
    v_mfma_f32_16x16x32_bf16 v[36:39], v[76:79], v[12:15], v[36:39]
    v_mfma_f32_16x16x32_bf16 v[40:43], v[84:87], v[12:15], v[40:43]
    v_mfma_f32_16x16x32_bf16 v[44:47], v[92:95], v[12:15], v[44:47]
    s_nop 4
    v_mov_b32_dpp v48, v32 quad_perm:[0,0,0,0] row_mask:0xf bank_mask:0xf
    v_mov_b32_dpp v49, v36 quad_perm:[0,0,0,0] row_mask:0xf bank_mask:0xf
    v_mov_b32_dpp v50, v40 quad_perm:[0,0,0,0] row_mask:0xf bank_mask:0xf
    v_mov_b32_dpp v51, v44 quad_perm:[0,0,0,0] row_mask:0xf bank_mask:0xf
    v_add_f32_dpp v48, v33, v48 quad_perm:[1,1,1,1] row_mask:0xf bank_mask:0xf
    v_add_f32_dpp v49, v37, v49 quad_perm:[1,1,1,1] row_mask:0xf bank_mask:0xf
    v_add_f32_dpp v50, v41, v50 quad_perm:[1,1,1,1] row_mask:0xf bank_mask:0xf
    v_add_f32_dpp v51, v45, v51 quad_perm:[1,1,1,1] row_mask:0xf bank_mask:0xf
    v_add_f32_dpp v48, v34, v48 quad_perm:[2,2,2,2] row_mask:0xf bank_mask:0xf
    v_add_f32_dpp v49, v38, v49 quad_perm:[2,2,2,2] row_mask:0xf bank_mask:0xf
    v_add_f32_dpp v50, v42, v50 quad_perm:[2,2,2,2] row_mask:0xf bank_mask:0xf
    v_add_f32_dpp v51, v46, v51 quad_perm:[2,2,2,2] row_mask:0xf bank_mask:0xf
    v_add_f32_dpp v48, v35, v48 quad_perm:[3,3,3,3] row_mask:0xf bank_mask:0xf
    v_add_f32_dpp v49, v39, v49 quad_perm:[3,3,3,3] row_mask:0xf bank_mask:0xf
    v_add_f32_dpp v50, v43, v50 quad_perm:[3,3,3,3] row_mask:0xf bank_mask:0xf
    v_add_f32_dpp v51, v47, v51 quad_perm:[3,3,3,3] row_mask:0xf bank_mask:0xf
    v_cvt_pk_bf16_f32 v52, v48, v49
    v_cvt_pk_bf16_f32 v53, v50, v51
    v_max3_f32 v28, v28, v48, v49
    ds_write_b64 v7, v[52:53] offset:30720
    v_max3_f32 v28, v28, v50, v51
L_k1:
    s_cmp_eq_u32 s46, 0
    s_cbranch_scc1 L_kc1
    s_xor_b32 s45, s45, s82
    s_xor_b32 s45, s45, s81
    s_xor_b32 s96, s45, s76
    s_xor_b32 s97, s45, s77
    s_xor_b32 s98, s96, s77
    v_xor_b32 v209, s45, v208
    s_waitcnt vmcnt(4)
    buffer_load_dwordx4 v[128:131], v209, s[32:35], 0 offen offset:0 nt
    buffer_load_dwordx4 v[132:135], v209, s[32:35], 0 offen offset:256 nt
    v_xor_b32 v209, s96, v208
    s_waitcnt vmcnt(4)
    buffer_load_dwordx4 v[136:139], v209, s[32:35], 0 offen offset:0 nt
    s_waitcnt vmcnt(4)
    buffer_load_dwordx4 v[140:143], v209, s[32:35], 0 offen offset:256 nt
    v_xor_b32 v209, s97, v208
    s_waitcnt vmcnt(4)
    buffer_load_dwordx4 v[144:147], v209, s[32:35], 0 offen offset:0 nt
    buffer_load_dwordx4 v[148:151], v209, s[32:35], 0 offen offset:256 nt
    v_xor_b32 v209, s98, v208
    s_waitcnt vmcnt(4)
    buffer_load_dwordx4 v[152:155], v209, s[32:35], 0 offen offset:0 nt
    s_waitcnt vmcnt(4)
    buffer_load_dwordx4 v[156:159], v209, s[32:35], 0 offen offset:256 nt
L_ka1:
    v_mfma_f32_16x16x32_bf16 v[32:35], v[96:99], v[8:11], 0
    v_mfma_f32_16x16x32_bf16 v[36:39], v[104:107], v[8:11], 0
    v_mfma_f32_16x16x32_bf16 v[40:43], v[112:115], v[8:11], 0
    v_mfma_f32_16x16x32_bf16 v[44:47], v[120:123], v[8:11], 0
    v_mfma_f32_16x16x32_bf16 v[32:35], v[100:103], v[12:15], v[32:35]
    v_mfma_f32_16x16x32_bf16 v[36:39], v[108:111], v[12:15], v[36:39]
    v_mfma_f32_16x16x32_bf16 v[40:43], v[116:119], v[12:15], v[40:43]
    v_mfma_f32_16x16x32_bf16 v[44:47], v[124:127], v[12:15], v[44:47]
    s_nop 4
    v_mov_b32_dpp v48, v32 quad_perm:[0,0,0,0] row_mask:0xf bank_mask:0xf
    v_mov_b32_dpp v49, v36 quad_perm:[0,0,0,0] row_mask:0xf bank_mask:0xf
    v_mov_b32_dpp v50, v40 quad_perm:[0,0,0,0] row_mask:0xf bank_mask:0xf
    v_mov_b32_dpp v51, v44 quad_perm:[0,0,0,0] row_mask:0xf bank_mask:0xf
    v_add_f32_dpp v48, v33, v48 quad_perm:[1,1,1,1] row_mask:0xf bank_mask:0xf
    v_add_f32_dpp v49, v37, v49 quad_perm:[1,1,1,1] row_mask:0xf bank_mask:0xf
    v_add_f32_dpp v50, v41, v50 quad_perm:[1,1,1,1] row_mask:0xf bank_mask:0xf
    v_add_f32_dpp v51, v45, v51 quad_perm:[1,1,1,1] row_mask:0xf bank_mask:0xf
    v_add_f32_dpp v48, v34, v48 quad_perm:[2,2,2,2] row_mask:0xf bank_mask:0xf
    v_add_f32_dpp v49, v38, v49 quad_perm:[2,2,2,2] row_mask:0xf bank_mask:0xf
    v_add_f32_dpp v50, v42, v50 quad_perm:[2,2,2,2] row_mask:0xf bank_mask:0xf
    v_add_f32_dpp v51, v46, v51 quad_perm:[2,2,2,2] row_mask:0xf bank_mask:0xf
    v_add_f32_dpp v48, v35, v48 quad_perm:[3,3,3,3] row_mask:0xf bank_mask:0xf
    v_add_f32_dpp v49, v39, v49 quad_perm:[3,3,3,3] row_mask:0xf bank_mask:0xf
    v_add_f32_dpp v50, v43, v50 quad_perm:[3,3,3,3] row_mask:0xf bank_mask:0xf
    v_add_f32_dpp v51, v47, v51 quad_perm:[3,3,3,3] row_mask:0xf bank_mask:0xf
    v_cvt_pk_bf16_f32 v52, v48, v49
    v_cvt_pk_bf16_f32 v53, v50, v51
    v_max3_f32 v28, v28, v48, v49
    ds_write_b64 v7, v[52:53] offset:30976
    v_max3_f32 v28, v28, v50, v51
    s_branch L_k2
L_tch4:
    s_branch L_tback
L_k2:
    s_cmp_eq_u32 s46, 0
    s_cbranch_scc1 L_kc2
    s_xor_b32 s45, s45, s81
    s_xor_b32 s96, s45, s76
    s_xor_b32 s97, s45, s77
    s_xor_b32 s98, s96, s77
    v_xor_b32 v209, s45, v208
    s_waitcnt vmcnt(4)
    buffer_load_dwordx4 v[160:163], v209, s[32:35], 0 offen offset:0 nt
    buffer_load_dwordx4 v[164:167], v209, s[32:35], 0 offen offset:256 nt
    v_xor_b32 v209, s96, v208
    s_waitcnt vmcnt(4)
    buffer_load_dwordx4 v[168:171], v209, s[32:35], 0 offen offset:0 nt
    s_waitcnt vmcnt(4)
    buffer_load_dwordx4 v[172:175], v209, s[32:35], 0 offen offset:256 nt
    v_xor_b32 v209, s97, v208
    s_waitcnt vmcnt(4)
    buffer_load_dwordx4 v[176:179], v209, s[32:35], 0 offen offset:0 nt
    buffer_load_dwordx4 v[180:183], v209, s[32:35], 0 offen offset:256 nt
    v_xor_b32 v209, s98, v208
    s_waitcnt vmcnt(4)
    buffer_load_dwordx4 v[184:187], v209, s[32:35], 0 offen offset:0 nt
    s_waitcnt vmcnt(4)
    buffer_load_dwordx4 v[188:191], v209, s[32:35], 0 offen offset:256 nt
L_ka2:
    v_mfma_f32_16x16x32_bf16 v[32:35], v[128:131], v[8:11], 0
    v_mfma_f32_16x16x32_bf16 v[36:39], v[136:139], v[8:11], 0
    v_mfma_f32_16x16x32_bf16 v[40:43], v[144:147], v[8:11], 0
    v_mfma_f32_16x16x32_bf16 v[44:47], v[152:155], v[8:11], 0
    v_mfma_f32_16x16x32_bf16 v[32:35], v[132:135], v[12:15], v[32:35]
    v_mfma_f32_16x16x32_bf16 v[36:39], v[140:143], v[12:15], v[36:39]
    v_mfma_f32_16x16x32_bf16 v[40:43], v[148:151], v[12:15], v[40:43]
    v_mfma_f32_16x16x32_bf16 v[44:47], v[156:159], v[12:15], v[44:47]
    s_nop 4
    v_mov_b32_dpp v48, v32 quad_perm:[0,0,0,0] row_mask:0xf bank_mask:0xf
    v_mov_b32_dpp v49, v36 quad_perm:[0,0,0,0] row_mask:0xf bank_mask:0xf
    v_mov_b32_dpp v50, v40 quad_perm:[0,0,0,0] row_mask:0xf bank_mask:0xf
    v_mov_b32_dpp v51, v44 quad_perm:[0,0,0,0] row_mask:0xf bank_mask:0xf
    v_add_f32_dpp v48, v33, v48 quad_perm:[1,1,1,1] row_mask:0xf bank_mask:0xf
    v_add_f32_dpp v49, v37, v49 quad_perm:[1,1,1,1] row_mask:0xf bank_mask:0xf
    v_add_f32_dpp v50, v41, v50 quad_perm:[1,1,1,1] row_mask:0xf bank_mask:0xf
    v_add_f32_dpp v51, v45, v51 quad_perm:[1,1,1,1] row_mask:0xf bank_mask:0xf
    v_add_f32_dpp v48, v34, v48 quad_perm:[2,2,2,2] row_mask:0xf bank_mask:0xf
    v_add_f32_dpp v49, v38, v49 quad_perm:[2,2,2,2] row_mask:0xf bank_mask:0xf
    v_add_f32_dpp v50, v42, v50 quad_perm:[2,2,2,2] row_mask:0xf bank_mask:0xf
    v_add_f32_dpp v51, v46, v51 quad_perm:[2,2,2,2] row_mask:0xf bank_mask:0xf
    v_add_f32_dpp v48, v35, v48 quad_perm:[3,3,3,3] row_mask:0xf bank_mask:0xf
    v_add_f32_dpp v49, v39, v49 quad_perm:[3,3,3,3] row_mask:0xf bank_mask:0xf
    v_add_f32_dpp v50, v43, v50 quad_perm:[3,3,3,3] row_mask:0xf bank_mask:0xf
    v_add_f32_dpp v51, v47, v51 quad_perm:[3,3,3,3] row_mask:0xf bank_mask:0xf
    v_cvt_pk_bf16_f32 v52, v48, v49
    v_cvt_pk_bf16_f32 v53, v50, v51
    v_max3_f32 v28, v28, v48, v49
    ds_write_b64 v7, v[52:53] offset:31232
    v_max3_f32 v28, v28, v50, v51
L_k3:
    s_cmp_eq_u32 s46, 0
    s_cbranch_scc1 L_kc3
    s_cmp_eq_u32 s46, 12
    s_cbranch_scc1 L_ktov
    s_cmp_eq_u32 s46, 4
    s_cselect_b32 s48, s84, 0
    s_xor_b32 s45, s45, s48
    s_xor_b32 s45, s45, s83
    s_xor_b32 s45, s45, s82
    s_xor_b32 s45, s45, s81
    s_xor_b32 s96, s45, s76
    s_xor_b32 s97, s45, s77
    s_xor_b32 s98, s96, s77
L_kgo:
    v_xor_b32 v209, s45, v208
    s_waitcnt vmcnt(4)
    buffer_load_dwordx4 v[64:67], v209, s[32:35], 0 offen offset:0 nt
    buffer_load_dwordx4 v[68:71], v209, s[32:35], 0 offen offset:256 nt
    v_xor_b32 v209, s96, v208
    s_waitcnt vmcnt(4)
    buffer_load_dwordx4 v[72:75], v209, s[32:35], 0 offen offset:0 nt
    s_waitcnt vmcnt(4)
    buffer_load_dwordx4 v[76:79], v209, s[32:35], 0 offen offset:256 nt
L_kc3:
    v_xor_b32 v209, s97, v208
    s_waitcnt vmcnt(4)
    buffer_load_dwordx4 v[80:83], v209, s[32:35], 0 offen offset:0 nt
    buffer_load_dwordx4 v[84:87], v209, s[32:35], 0 offen offset:256 nt
    v_xor_b32 v209, s98, v208
    s_waitcnt vmcnt(4)
    buffer_load_dwordx4 v[88:91], v209, s[32:35], 0 offen offset:0 nt
    s_waitcnt vmcnt(4)
    buffer_load_dwordx4 v[92:95], v209, s[32:35], 0 offen offset:256 nt
L_ka3:
    v_mfma_f32_16x16x32_bf16 v[32:35], v[160:163], v[8:11], 0
    v_mfma_f32_16x16x32_bf16 v[36:39], v[168:171], v[8:11], 0
    v_mfma_f32_16x16x32_bf16 v[40:43], v[176:179], v[8:11], 0
    v_mfma_f32_16x16x32_bf16 v[44:47], v[184:187], v[8:11], 0
    v_mfma_f32_16x16x32_bf16 v[32:35], v[164:167], v[12:15], v[32:35]
    v_mfma_f32_16x16x32_bf16 v[36:39], v[172:175], v[12:15], v[36:39]
    v_mfma_f32_16x16x32_bf16 v[40:43], v[180:183], v[12:15], v[40:43]
    v_mfma_f32_16x16x32_bf16 v[44:47], v[188:191], v[12:15], v[44:47]
    s_nop 4
    v_mov_b32_dpp v48, v32 quad_perm:[0,0,0,0] row_mask:0xf bank_mask:0xf
    v_mov_b32_dpp v49, v36 quad_perm:[0,0,0,0] row_mask:0xf bank_mask:0xf
    v_mov_b32_dpp v50, v40 quad_perm:[0,0,0,0] row_mask:0xf bank_mask:0xf
    v_mov_b32_dpp v51, v44 quad_perm:[0,0,0,0] row_mask:0xf bank_mask:0xf
    v_add_f32_dpp v48, v33, v48 quad_perm:[1,1,1,1] row_mask:0xf bank_mask:0xf
    v_add_f32_dpp v49, v37, v49 quad_perm:[1,1,1,1] row_mask:0xf bank_mask:0xf
    v_add_f32_dpp v50, v41, v50 quad_perm:[1,1,1,1] row_mask:0xf bank_mask:0xf
    v_add_f32_dpp v51, v45, v51 quad_perm:[1,1,1,1] row_mask:0xf bank_mask:0xf
    v_add_f32_dpp v48, v34, v48 quad_perm:[2,2,2,2] row_mask:0xf bank_mask:0xf
    v_add_f32_dpp v49, v38, v49 quad_perm:[2,2,2,2] row_mask:0xf bank_mask:0xf
    v_add_f32_dpp v50, v42, v50 quad_perm:[2,2,2,2] row_mask:0xf bank_mask:0xf
    v_add_f32_dpp v51, v46, v51 quad_perm:[2,2,2,2] row_mask:0xf bank_mask:0xf
    v_add_f32_dpp v48, v35, v48 quad_perm:[3,3,3,3] row_mask:0xf bank_mask:0xf
    v_add_f32_dpp v49, v39, v49 quad_perm:[3,3,3,3] row_mask:0xf bank_mask:0xf
    v_add_f32_dpp v50, v43, v50 quad_perm:[3,3,3,3] row_mask:0xf bank_mask:0xf
    v_add_f32_dpp v51, v47, v51 quad_perm:[3,3,3,3] row_mask:0xf bank_mask:0xf
    v_cvt_pk_bf16_f32 v52, v48, v49
    v_cvt_pk_bf16_f32 v53, v50, v51
    v_max3_f32 v28, v28, v48, v49
    ds_write_b64 v7, v[52:53] offset:31488
    v_max3_f32 v28, v28, v50, v51
    v_add_u32 v7, 1024, v7
    s_add_u32 s46, s46, 4
    s_cmp_lt_u32 s46, 16
    s_cbranch_scc1 L_k0
    s_mov_b64 exec, 1
    ds_add_u32 v6, v206 offset:17416
    s_mov_b64 exec, -1
    v_subrev_u32 v7, 3584, v7
    v_mov_b32 v48, v28
    ds_read_b64 v[60:61], v7 offset:30720
    s_mov_b32 s46, 1
    v_permlane16_swap_b32 v28, v48
    v_max_f32 v28, v28, v48
    v_mov_b32 v48, v28
    s_nop 1
    v_permlane32_swap_b32 v28, v48
    v_max_f32 v28, v28, v48
    v_cvt_pk_bf16_f32 v28, v28, v28
    v_and_b32 v28, 0xffff0000, v28
    v_mul_f32 v29, s52, v28
    s_branch L_v0
L_kc1:
    s_xor_b32 s45, s38, s83
    s_xor_b32 s96, s45, s76
    s_xor_b32 s97, s45, s77
    s_xor_b32 s98, s96, s77
    s_cmp_eq_u32 s46, 0
    v_xor_b32 v209, s45, v208
    s_waitcnt vmcnt(4)
    buffer_load_dwordx4 v[64:67], v209, s[32:35], 0 offen offset:0 nt
    buffer_load_dwordx4 v[68:71], v209, s[32:35], 0 offen offset:256 nt
    s_branch L_ka1
L_kc2:
    v_xor_b32 v209, s96, v208
    s_waitcnt vmcnt(4)
    buffer_load_dwordx4 v[72:75], v209, s[32:35], 0 offen offset:0 nt
    s_waitcnt vmcnt(4)
    buffer_load_dwordx4 v[76:79], v209, s[32:35], 0 offen offset:256 nt
    s_branch L_ka2
.fill (((gated_mix__gqa_block_cached__glu_gated_glu__decode_kernel - .) & 4095) >> 2), 4, 0xbf810000
L_tch5:
    s_branch L_tch6
L_ktov:
    s_mov_b32 s32, s36
    s_mov_b32 s33, s37
    s_mov_b32 s49, 3
    v_lshlrev_b32 v208, 4, v3
    v_bfe_i32 v1, v2, 0, 1
    v_and_b32 v1, 0x19200, v1
    v_xor_b32 v208, v208, v1
    v_bfe_i32 v1, v2, 1, 1
    v_and_b32 v1, 0x103200, v1
    v_xor_b32 v208, v208, v1
    s_xor_b32 s45, s38, s82
    s_xor_b32 s96, s45, s76
    s_xor_b32 s97, s45, s77
    s_xor_b32 s98, s96, s77
    s_branch L_kgo
L_v0:
    s_waitcnt lgkmcnt(0)
    s_cmp_lt_u32 s46, 14
    s_cbranch_scc0 L_vd0
    v_add_u32 v7, 256, v7
    s_xor_b32 s45, s45, s81
    s_xor_b32 s96, s45, s76
    s_xor_b32 s97, s45, s77
    s_xor_b32 s98, s96, s77
    s_add_u32 s49, s49, 1
    ds_read_b64 v[62:63], v7 offset:30720
    v_xor_b32 v209, s45, v208
    s_waitcnt vmcnt(4)
    buffer_load_dwordx4 v[96:99], v209, s[32:35], 0 offen offset:0 nt
    buffer_load_dwordx4 v[100:103], v209, s[32:35], 0 offen offset:256 nt
    v_xor_b32 v209, s96, v208
    s_waitcnt vmcnt(4)
    buffer_load_dwordx4 v[104:107], v209, s[32:35], 0 offen offset:0 nt
    s_waitcnt vmcnt(4)
    buffer_load_dwordx4 v[108:111], v209, s[32:35], 0 offen offset:256 nt
L_vb0:
    s_add_u32 s46, s46, 1
    s_cmp_lt_u32 s46, 14
    s_cbranch_scc1 L_noat0
    s_cmp_eq_u32 s46, 14
    s_cbranch_scc1 L_norm
L_normx:
    s_mov_b32 s53, 1
    s_atomic_add s53, s[50:51], 0 glc
L_noat0:
    v_lshlrev_b32 v48, 16, v60
    v_and_b32 v49, 0xffff0000, v60
    v_lshlrev_b32 v50, 16, v61
    v_and_b32 v51, 0xffff0000, v61
    v_fma_f32 v48, v48, s52, -v29
    v_fma_f32 v49, v49, s52, -v29
    v_fma_f32 v50, v50, s52, -v29
    v_fma_f32 v51, v51, s52, -v29
    v_exp_f32 v48, v48
    v_exp_f32 v49, v49
    v_exp_f32 v50, v50
    v_exp_f32 v51, v51
    v_cvt_pk_bf16_f32 v48, v48, v48
    v_cvt_pk_bf16_f32 v49, v49, v49
    v_cvt_pk_bf16_f32 v50, v50, v50
    v_cvt_pk_bf16_f32 v51, v51, v51
    v_and_b32 v32, v48, v16
    v_and_b32 v33, v48, v17
    v_and_b32 v34, v48, v18
    v_and_b32 v35, v48, v19
    v_and_b32 v36, v49, v16
    v_and_b32 v37, v49, v17
    v_and_b32 v38, v49, v18
    v_and_b32 v39, v49, v19
    v_and_b32 v40, v50, v16
    v_and_b32 v41, v50, v17
    v_and_b32 v42, v50, v18
    v_and_b32 v43, v50, v19
    v_and_b32 v44, v51, v16
    v_and_b32 v45, v51, v17
    v_and_b32 v46, v51, v18
    v_and_b32 v47, v51, v19
    s_cmp_eq_u32 s57, 1
    s_cbranch_scc1 L_vh0
    s_waitcnt vmcnt(5)
    s_cmp_le_u32 s46, 14
    s_cbranch_scc0 L_vc0
    s_waitcnt vmcnt(4)
L_vc0:
    v_xor_b32 v209, s97, v208
    buffer_load_dwordx4 v[112:115], v209, s[32:35], 0 offen offset:0 nt
    buffer_load_dwordx4 v[116:119], v209, s[32:35], 0 offen offset:256 nt
    v_xor_b32 v209, s98, v208
    s_waitcnt vmcnt(4)
    buffer_load_dwordx4 v[120:123], v209, s[32:35], 0 offen offset:0 nt
    s_waitcnt vmcnt(4)
    buffer_load_dwordx4 v[124:127], v209, s[32:35], 0 offen offset:256 nt
L_vp0:
    v_mfma_f32_16x16x32_bf16 v[20:23], v[32:35], v[64:67], v[20:23]
    v_mfma_f32_16x16x32_bf16 v[24:27], v[32:35], v[68:71], v[24:27]
    v_mfma_f32_16x16x32_bf16 v[20:23], v[36:39], v[72:75], v[20:23]
    v_mfma_f32_16x16x32_bf16 v[24:27], v[36:39], v[76:79], v[24:27]
    v_mfma_f32_16x16x32_bf16 v[20:23], v[40:43], v[80:83], v[20:23]
    v_mfma_f32_16x16x32_bf16 v[24:27], v[40:43], v[84:87], v[24:27]
    v_mfma_f32_16x16x32_bf16 v[20:23], v[44:47], v[88:91], v[20:23]
    v_mfma_f32_16x16x32_bf16 v[24:27], v[44:47], v[92:95], v[24:27]
L_v1:
    s_waitcnt lgkmcnt(0)
    s_cmp_lt_u32 s46, 14
    s_cbranch_scc0 L_vd1
    v_add_u32 v7, 256, v7
    s_xor_b32 s45, s45, s81
    s_xor_b32 s45, s45, s82
    s_and_b32 s48, s49, 3
    s_cselect_b32 s48, 0, s83
    s_xor_b32 s45, s45, s48
    s_and_b32 s48, s49, 7
    s_cselect_b32 s48, 0, s84
    s_xor_b32 s45, s45, s48
    s_xor_b32 s96, s45, s76
    s_xor_b32 s97, s45, s77
    s_xor_b32 s98, s96, s77
    s_add_u32 s49, s49, 1
    ds_read_b64 v[60:61], v7 offset:30720
    v_xor_b32 v209, s45, v208
    s_waitcnt vmcnt(4)
    buffer_load_dwordx4 v[64:67], v209, s[32:35], 0 offen offset:0 nt
    buffer_load_dwordx4 v[68:71], v209, s[32:35], 0 offen offset:256 nt
    v_xor_b32 v209, s96, v208
    s_waitcnt vmcnt(4)
    buffer_load_dwordx4 v[72:75], v209, s[32:35], 0 offen offset:0 nt
    s_waitcnt vmcnt(4)
    buffer_load_dwordx4 v[76:79], v209, s[32:35], 0 offen offset:256 nt
L_vb1:
    s_add_u32 s46, s46, 1
    s_cmp_lt_u32 s46, 14
    s_cbranch_scc1 L_noat1
    s_mov_b32 s53, 1
    s_atomic_add s53, s[50:51], 0 glc
L_noat1:
    v_lshlrev_b32 v48, 16, v62
    v_and_b32 v49, 0xffff0000, v62
    v_lshlrev_b32 v50, 16, v63
    v_and_b32 v51, 0xffff0000, v63
    v_fma_f32 v48, v48, s52, -v29
    v_fma_f32 v49, v49, s52, -v29
    v_fma_f32 v50, v50, s52, -v29
    v_fma_f32 v51, v51, s52, -v29
    v_exp_f32 v48, v48
    v_exp_f32 v49, v49
    v_exp_f32 v50, v50
    v_exp_f32 v51, v51
    v_cvt_pk_bf16_f32 v48, v48, v48
    v_cvt_pk_bf16_f32 v49, v49, v49
    v_cvt_pk_bf16_f32 v50, v50, v50
    v_cvt_pk_bf16_f32 v51, v51, v51
    v_and_b32 v32, v48, v16
    v_and_b32 v33, v48, v17
    v_and_b32 v34, v48, v18
    v_and_b32 v35, v48, v19
    v_and_b32 v36, v49, v16
    v_and_b32 v37, v49, v17
    v_and_b32 v38, v49, v18
    v_and_b32 v39, v49, v19
    v_and_b32 v40, v50, v16
    v_and_b32 v41, v50, v17
    v_and_b32 v42, v50, v18
    v_and_b32 v43, v50, v19
    v_and_b32 v44, v51, v16
    v_and_b32 v45, v51, v17
    v_and_b32 v46, v51, v18
    v_and_b32 v47, v51, v19
    s_cmp_eq_u32 s57, 1
    s_cbranch_scc1 L_vh1
    s_waitcnt vmcnt(5)
    s_cmp_le_u32 s46, 14
    s_cbranch_scc0 L_vc1
    s_waitcnt vmcnt(4)
L_vc1:
    v_xor_b32 v209, s97, v208
    buffer_load_dwordx4 v[80:83], v209, s[32:35], 0 offen offset:0 nt
    buffer_load_dwordx4 v[84:87], v209, s[32:35], 0 offen offset:256 nt
    v_xor_b32 v209, s98, v208
    s_waitcnt vmcnt(4)
    buffer_load_dwordx4 v[88:91], v209, s[32:35], 0 offen offset:0 nt
    s_waitcnt vmcnt(4)
    buffer_load_dwordx4 v[92:95], v209, s[32:35], 0 offen offset:256 nt
    s_cmp_eq_u32 s46, 9
    s_cbranch_scc0 L_vp1
    ds_write_b32 v6, v206 offset:17428
L_vp1:
    v_mfma_f32_16x16x32_bf16 v[20:23], v[32:35], v[96:99], v[20:23]
    v_mfma_f32_16x16x32_bf16 v[24:27], v[32:35], v[100:103], v[24:27]
    v_mfma_f32_16x16x32_bf16 v[20:23], v[36:39], v[104:107], v[20:23]
    v_mfma_f32_16x16x32_bf16 v[24:27], v[36:39], v[108:111], v[24:27]
    v_mfma_f32_16x16x32_bf16 v[20:23], v[40:43], v[112:115], v[20:23]
    v_mfma_f32_16x16x32_bf16 v[24:27], v[40:43], v[116:119], v[24:27]
    v_mfma_f32_16x16x32_bf16 v[20:23], v[44:47], v[120:123], v[20:23]
    v_mfma_f32_16x16x32_bf16 v[24:27], v[44:47], v[124:127], v[24:27]
    s_branch L_v0
L_tch6:
    s_branch L_tch7
L_vd0:
    s_cmp_ge_u32 s53, 44
    s_cbranch_scc1 L_dry0
    s_sub_u32 s56, s53, 20
    s_cselect_b32 s56, 0, s56
    s_cselect_b32 s57, 0, 1
    s_add_u32 s54, s56, 1
    s_lshr_b32 s54, s54, 1
    s_sub_u32 s53, s53, s54
    s_and_b32 s56, s56, 1
    s_cmp_ge_u32 s53, 16
    s_cselect_b32 s55, 16, 0
    s_add_u32 s53, s53, s55
    s_lshl_b32 s55, s53, 6
    s_add_u32 s55, s55, s58
    s_bitcmp1_b32 s53, 0
    s_cselect_b32 s48, s78, 0
    s_xor_b32 s45, s47, s48
    s_bitcmp1_b32 s53, 1
    s_cselect_b32 s48, s79, 0
    s_xor_b32 s45, s45, s48
    s_bitcmp1_b32 s53, 2
    s_cselect_b32 s48, s80, 0
    s_xor_b32 s45, s45, s48
    s_bitcmp1_b32 s53, 3
    s_cselect_b32 s48, s81, 0
    s_xor_b32 s45, s45, s48
    s_bitcmp1_b32 s53, 4
    s_cselect_b32 s48, s82, 0
    s_xor_b32 s45, s45, s48
    s_bitcmp1_b32 s53, 5
    s_cselect_b32 s48, s85, 0
    s_xor_b32 s45, s45, s48
    s_xor_b32 s96, s45, s76
    s_xor_b32 s97, s45, s77
    s_xor_b32 s98, s96, s77
    s_cmp_eq_u32 s57, 0
    s_cbranch_scc1 L_vf0
    s_lshl_b32 s54, s56, 2
    s_add_u32 s55, s55, s54
    s_cmp_eq_u32 s56, 0
    s_cselect_b32 s97, s45, s97
    s_cselect_b32 s98, s96, s98
    v_mov_b32 v62, 0xff80ff80
    s_waitcnt vmcnt(4)
    buffer_load_dword v63, v30, s[40:43], s55 offen sc1
    v_xor_b32 v209, s97, v208
    buffer_load_dwordx4 v[112:115], v209, s[32:35], 0 offen offset:0 nt
    buffer_load_dwordx4 v[116:119], v209, s[32:35], 0 offen offset:256 nt
    s_branch L_vb0
L_vh0:
    s_waitcnt vmcnt(5)
    v_xor_b32 v209, s98, v208
    buffer_load_dwordx4 v[120:123], v209, s[32:35], 0 offen offset:0 nt
    buffer_load_dwordx4 v[124:127], v209, s[32:35], 0 offen offset:256 nt
    s_waitcnt vmcnt(5)
    s_branch L_vp0
L_vf0:
    s_waitcnt vmcnt(4)
    buffer_load_dwordx2 v[62:63], v30, s[40:43], s55 offen sc1
    v_xor_b32 v209, s45, v208
    buffer_load_dwordx4 v[96:99], v209, s[32:35], 0 offen offset:0 nt
    buffer_load_dwordx4 v[100:103], v209, s[32:35], 0 offen offset:256 nt
    v_xor_b32 v209, s96, v208
    s_waitcnt vmcnt(5)
    buffer_load_dwordx4 v[104:107], v209, s[32:35], 0 offen offset:0 nt
    s_waitcnt vmcnt(5)
    buffer_load_dwordx4 v[108:111], v209, s[32:35], 0 offen offset:256 nt
    s_branch L_vb0
L_vd1:
    s_cmp_ge_u32 s53, 44
    s_cbranch_scc1 L_dry1
    s_sub_u32 s56, s53, 20
    s_cselect_b32 s56, 0, s56
    s_cselect_b32 s57, 0, 1
    s_add_u32 s54, s56, 1
    s_lshr_b32 s54, s54, 1
    s_sub_u32 s53, s53, s54
    s_and_b32 s56, s56, 1
    s_cmp_ge_u32 s53, 16
    s_cselect_b32 s55, 16, 0
    s_add_u32 s53, s53, s55
    s_lshl_b32 s55, s53, 6
    s_add_u32 s55, s55, s58
    s_bitcmp1_b32 s53, 0
    s_cselect_b32 s48, s78, 0
    s_xor_b32 s45, s47, s48
    s_bitcmp1_b32 s53, 1
    s_cselect_b32 s48, s79, 0
    s_xor_b32 s45, s45, s48
    s_bitcmp1_b32 s53, 2
    s_cselect_b32 s48, s80, 0
    s_xor_b32 s45, s45, s48
    s_bitcmp1_b32 s53, 3
    s_cselect_b32 s48, s81, 0
    s_xor_b32 s45, s45, s48
    s_bitcmp1_b32 s53, 4
    s_cselect_b32 s48, s82, 0
    s_xor_b32 s45, s45, s48
    s_bitcmp1_b32 s53, 5
    s_cselect_b32 s48, s85, 0
    s_xor_b32 s45, s45, s48
    s_xor_b32 s96, s45, s76
    s_xor_b32 s97, s45, s77
    s_xor_b32 s98, s96, s77
    s_cmp_eq_u32 s57, 0
    s_cbranch_scc1 L_vf1
    s_lshl_b32 s54, s56, 2
    s_add_u32 s55, s55, s54
    s_cmp_eq_u32 s56, 0
    s_cselect_b32 s97, s45, s97
    s_cselect_b32 s98, s96, s98
    v_mov_b32 v60, 0xff80ff80
    s_waitcnt vmcnt(4)
    buffer_load_dword v61, v30, s[40:43], s55 offen sc1
    v_xor_b32 v209, s97, v208
    buffer_load_dwordx4 v[80:83], v209, s[32:35], 0 offen offset:0 nt
    buffer_load_dwordx4 v[84:87], v209, s[32:35], 0 offen offset:256 nt
    s_branch L_vb1
L_vh1:
    s_waitcnt vmcnt(5)
    v_xor_b32 v209, s98, v208
    buffer_load_dwordx4 v[88:91], v209, s[32:35], 0 offen offset:0 nt
    buffer_load_dwordx4 v[92:95], v209, s[32:35], 0 offen offset:256 nt
    s_waitcnt vmcnt(5)
    s_branch L_vp1
L_vf1:
    s_waitcnt vmcnt(4)
    buffer_load_dwordx2 v[60:61], v30, s[40:43], s55 offen sc1
    v_xor_b32 v209, s45, v208
    buffer_load_dwordx4 v[64:67], v209, s[32:35], 0 offen offset:0 nt
    buffer_load_dwordx4 v[68:71], v209, s[32:35], 0 offen offset:256 nt
    v_xor_b32 v209, s96, v208
    s_waitcnt vmcnt(5)
    buffer_load_dwordx4 v[72:75], v209, s[32:35], 0 offen offset:0 nt
    s_waitcnt vmcnt(5)
    buffer_load_dwordx4 v[76:79], v209, s[32:35], 0 offen offset:256 nt
    s_branch L_vb1
L_tch7:
    s_branch L_tch10
L_dry0:
    s_cmp_eq_u32 s57, 0
    s_cbranch_scc1 L_dw0
    s_waitcnt vmcnt(4)
L_dw0:
    s_waitcnt vmcnt(8)
    v_lshlrev_b32 v48, 16, v60
    v_and_b32 v49, 0xffff0000, v60
    v_lshlrev_b32 v50, 16, v61
    v_and_b32 v51, 0xffff0000, v61
    v_fma_f32 v48, v48, s52, -v29
    v_fma_f32 v49, v49, s52, -v29
    v_fma_f32 v50, v50, s52, -v29
    v_fma_f32 v51, v51, s52, -v29
    v_exp_f32 v48, v48
    v_exp_f32 v49, v49
    v_exp_f32 v50, v50
    v_exp_f32 v51, v51
    v_cvt_pk_bf16_f32 v48, v48, v48
    v_cvt_pk_bf16_f32 v49, v49, v49
    v_cvt_pk_bf16_f32 v50, v50, v50
    v_cvt_pk_bf16_f32 v51, v51, v51
    v_and_b32 v32, v48, v16
    v_and_b32 v33, v48, v17
    v_and_b32 v34, v48, v18
    v_and_b32 v35, v48, v19
    v_and_b32 v36, v49, v16
    v_and_b32 v37, v49, v17
    v_and_b32 v38, v49, v18
    v_and_b32 v39, v49, v19
    v_and_b32 v40, v50, v16
    v_and_b32 v41, v50, v17
    v_and_b32 v42, v50, v18
    v_and_b32 v43, v50, v19
    v_and_b32 v44, v51, v16
    v_and_b32 v45, v51, v17
    v_and_b32 v46, v51, v18
    v_and_b32 v47, v51, v19
    s_mov_b32 s59, 400000
    s_waitcnt vmcnt(4)
    s_mov_b64 exec, 1
    s_waitcnt vmcnt(4)
    ds_add_rtn_u32 v49, v6, v206 offset:17420
    s_mov_b64 exec, -1
    v_mfma_f32_16x16x32_bf16 v[20:23], v[32:35], v[64:67], v[20:23]
    v_mfma_f32_16x16x32_bf16 v[24:27], v[32:35], v[68:71], v[24:27]
    v_mfma_f32_16x16x32_bf16 v[20:23], v[36:39], v[72:75], v[20:23]
    v_mfma_f32_16x16x32_bf16 v[24:27], v[36:39], v[76:79], v[24:27]
    ds_read_b32 v48, v6 offset:17424
    ds_read_b128 v[52:55], v195 offset:18432
    ds_read_b128 v[56:59], v195 offset:19456
    ds_read_b128 v[176:179], v195 offset:20480
    ds_read_b128 v[180:183], v195 offset:21504
    ds_read_b128 v[184:187], v195 offset:22528
    ds_read_b128 v[188:191], v195 offset:23552
    s_waitcnt lgkmcnt(7)
    v_readfirstlane_b32 s54, v49
    s_cmp_eq_u32 s54, 3
    s_cbranch_scc0 L_nr0
    s_mov_b64 exec, 15
    buffer_atomic_add v206, v207, s[40:43], s30 offen sc1
    s_mov_b64 exec, -1
    s_waitcnt lgkmcnt(6)
    v_cmp_gt_u32 vcc, 3, v48
    s_cbranch_vccnz L_na0
    s_waitcnt lgkmcnt(2)
    v_pk_add_f32 v[52:53], v[52:53], v[176:177]
    v_pk_add_f32 v[54:55], v[54:55], v[178:179]
    v_pk_add_f32 v[56:57], v[56:57], v[180:181]
    v_pk_add_f32 v[58:59], v[58:59], v[182:183]
    s_waitcnt lgkmcnt(0)
    v_pk_add_f32 v[52:53], v[52:53], v[184:185]
    v_pk_add_f32 v[54:55], v[54:55], v[186:187]
    v_pk_add_f32 v[56:57], v[56:57], v[188:189]
    v_pk_add_f32 v[58:59], v[58:59], v[190:191]
    v_pk_add_f32 v[20:21], v[20:21], v[52:53]
    v_pk_add_f32 v[22:23], v[22:23], v[54:55]
    v_pk_add_f32 v[24:25], v[24:25], v[56:57]
    v_pk_add_f32 v[26:27], v[26:27], v[58:59]
L_na0:
    s_waitcnt vmcnt(1)
    s_nop 0
    v_mfma_f32_16x16x32_bf16 v[20:23], v[40:43], v[80:83], v[20:23]
    v_mfma_f32_16x16x32_bf16 v[24:27], v[40:43], v[84:87], v[24:27]
    v_mfma_f32_16x16x32_bf16 v[20:23], v[44:47], v[88:91], v[20:23]
    v_mfma_f32_16x16x32_bf16 v[24:27], v[44:47], v[92:95], v[24:27]
    s_cbranch_vccnz L_fin
    s_nop 4
    s_branch L_pub
L_nr0:
    s_waitcnt vmcnt(0)
    v_mfma_f32_16x16x32_bf16 v[20:23], v[40:43], v[80:83], v[20:23]
    v_mfma_f32_16x16x32_bf16 v[24:27], v[40:43], v[84:87], v[24:27]
    v_mfma_f32_16x16x32_bf16 v[20:23], v[44:47], v[88:91], v[20:23]
    v_mfma_f32_16x16x32_bf16 v[24:27], v[44:47], v[92:95], v[24:27]
    s_branch L_park
L_tch10:
    s_branch L_tch8
L_dry1:
    s_cmp_eq_u32 s57, 0
    s_cbranch_scc1 L_dw1
    s_waitcnt vmcnt(4)
L_dw1:
    s_waitcnt vmcnt(8)
    v_lshlrev_b32 v48, 16, v62
    v_and_b32 v49, 0xffff0000, v62
    v_lshlrev_b32 v50, 16, v63
    v_and_b32 v51, 0xffff0000, v63
    v_fma_f32 v48, v48, s52, -v29
    v_fma_f32 v49, v49, s52, -v29
    v_fma_f32 v50, v50, s52, -v29
    v_fma_f32 v51, v51, s52, -v29
    v_exp_f32 v48, v48
    v_exp_f32 v49, v49
    v_exp_f32 v50, v50
    v_exp_f32 v51, v51
    v_cvt_pk_bf16_f32 v48, v48, v48
    v_cvt_pk_bf16_f32 v49, v49, v49
    v_cvt_pk_bf16_f32 v50, v50, v50
    v_cvt_pk_bf16_f32 v51, v51, v51
    v_and_b32 v32, v48, v16
    v_and_b32 v33, v48, v17
    v_and_b32 v34, v48, v18
    v_and_b32 v35, v48, v19
    v_and_b32 v36, v49, v16
    v_and_b32 v37, v49, v17
    v_and_b32 v38, v49, v18
    v_and_b32 v39, v49, v19
    v_and_b32 v40, v50, v16
    v_and_b32 v41, v50, v17
    v_and_b32 v42, v50, v18
    v_and_b32 v43, v50, v19
    v_and_b32 v44, v51, v16
    v_and_b32 v45, v51, v17
    v_and_b32 v46, v51, v18
    v_and_b32 v47, v51, v19
    s_mov_b32 s59, 400000
    s_waitcnt vmcnt(4)
    s_mov_b64 exec, 1
    s_waitcnt vmcnt(4)
    ds_add_rtn_u32 v49, v6, v206 offset:17420
    s_mov_b64 exec, -1
    v_mfma_f32_16x16x32_bf16 v[20:23], v[32:35], v[96:99], v[20:23]
    v_mfma_f32_16x16x32_bf16 v[24:27], v[32:35], v[100:103], v[24:27]
    v_mfma_f32_16x16x32_bf16 v[20:23], v[36:39], v[104:107], v[20:23]
    v_mfma_f32_16x16x32_bf16 v[24:27], v[36:39], v[108:111], v[24:27]
    ds_read_b32 v48, v6 offset:17424
    ds_read_b128 v[52:55], v195 offset:18432
    ds_read_b128 v[56:59], v195 offset:19456
    ds_read_b128 v[176:179], v195 offset:20480
    ds_read_b128 v[180:183], v195 offset:21504
    ds_read_b128 v[184:187], v195 offset:22528
    ds_read_b128 v[188:191], v195 offset:23552
    s_waitcnt lgkmcnt(7)
    v_readfirstlane_b32 s54, v49
    s_cmp_eq_u32 s54, 3
    s_cbranch_scc0 L_nr1
    s_mov_b64 exec, 15
    buffer_atomic_add v206, v207, s[40:43], s30 offen sc1
    s_mov_b64 exec, -1
    s_waitcnt lgkmcnt(6)
    v_cmp_gt_u32 vcc, 3, v48
    s_cbranch_vccnz L_na1
    s_waitcnt lgkmcnt(2)
    v_pk_add_f32 v[52:53], v[52:53], v[176:177]
    v_pk_add_f32 v[54:55], v[54:55], v[178:179]
    v_pk_add_f32 v[56:57], v[56:57], v[180:181]
    v_pk_add_f32 v[58:59], v[58:59], v[182:183]
    s_waitcnt lgkmcnt(0)
    v_pk_add_f32 v[52:53], v[52:53], v[184:185]
    v_pk_add_f32 v[54:55], v[54:55], v[186:187]
    v_pk_add_f32 v[56:57], v[56:57], v[188:189]
    v_pk_add_f32 v[58:59], v[58:59], v[190:191]
    v_pk_add_f32 v[20:21], v[20:21], v[52:53]
    v_pk_add_f32 v[22:23], v[22:23], v[54:55]
    v_pk_add_f32 v[24:25], v[24:25], v[56:57]
    v_pk_add_f32 v[26:27], v[26:27], v[58:59]
L_na1:
    s_waitcnt vmcnt(1)
    s_nop 0
    v_mfma_f32_16x16x32_bf16 v[20:23], v[40:43], v[112:115], v[20:23]
    v_mfma_f32_16x16x32_bf16 v[24:27], v[40:43], v[116:119], v[24:27]
    v_mfma_f32_16x16x32_bf16 v[20:23], v[44:47], v[120:123], v[20:23]
    v_mfma_f32_16x16x32_bf16 v[24:27], v[44:47], v[124:127], v[24:27]
    s_cbranch_vccnz L_fin
    s_nop 4
    s_branch L_pub
L_nr1:
    s_waitcnt vmcnt(0)
    v_mfma_f32_16x16x32_bf16 v[20:23], v[40:43], v[112:115], v[20:23]
    v_mfma_f32_16x16x32_bf16 v[24:27], v[40:43], v[116:119], v[24:27]
    v_mfma_f32_16x16x32_bf16 v[20:23], v[44:47], v[120:123], v[20:23]
    v_mfma_f32_16x16x32_bf16 v[24:27], v[44:47], v[124:127], v[24:27]
L_park:
    s_nop 5
    s_lshl_b32 s54, s54, 11
    v_add_u32 v49, s54, v195
    ds_write_b128 v49, v[20:23] offset:18432
    ds_write_b128 v49, v[24:27] offset:19456
    s_mov_b64 exec, 1
    ds_add_u32 v6, v206 offset:17424
    s_mov_b64 exec, -1
    s_cmp_ge_u32 s2, 224
    s_cbranch_scc1 L_sdone
    s_mov_b32 s55, s54
    s_cmp_eq_u32 s54, 0
    s_cbranch_scc1 L_wd
    s_cmp_eq_u32 s54, 2048
    s_cselect_b32 s48, 3584, 0
    s_cselect_b32 s54, 8192, 0
    s_add_u32 s12, s12, s48
    s_add_u32 m0, s54, 34816
    s_add_u32 s54, s54, 43008
L_wol:
    buffer_load_dwordx4 v192, s[4:7], s12 offen nt lds
    s_add_u32 m0, m0, 1024
    s_add_u32 s12, s12, 14336
    s_cmp_lt_u32 m0, s54
    s_cbranch_scc1 L_wol
    s_branch L_wx
L_wd:
    s_mov_b32 m0, 51200
    s_nop 0
L_wdl:
    buffer_load_dwordx4 v193, s[8:11], s13 offen nt lds
    s_add_u32 m0, m0, 1024
    s_add_u32 s13, s13, 7168
    s_cmp_lt_u32 m0, 59392
    s_cbranch_scc1 L_wdl
L_wx:
    s_cmp_eq_u32 s55, 4096
    s_cbranch_scc1 L_bw0
    s_branch L_bwx
L_tch8:
    s_branch L_tch9
L_fin:
    ds_read_b32 v48, v6 offset:17424
    ds_read_b128 v[52:55], v195 offset:18432
    ds_read_b128 v[56:59], v195 offset:19456
    ds_read_b128 v[176:179], v195 offset:20480
    ds_read_b128 v[180:183], v195 offset:21504
    ds_read_b128 v[184:187], v195 offset:22528
    ds_read_b128 v[188:191], v195 offset:23552
    s_sub_u32 s59, s59, 1
    s_cbranch_scc1 L_finx
    s_waitcnt lgkmcnt(6)
    v_cmp_gt_u32 vcc, 3, v48
    s_cbranch_vccnz L_fin
L_finx:
    s_waitcnt lgkmcnt(2)
    v_pk_add_f32 v[52:53], v[52:53], v[176:177]
    v_pk_add_f32 v[54:55], v[54:55], v[178:179]
    v_pk_add_f32 v[56:57], v[56:57], v[180:181]
    v_pk_add_f32 v[58:59], v[58:59], v[182:183]
    s_waitcnt lgkmcnt(0)
    v_pk_add_f32 v[52:53], v[52:53], v[184:185]
    v_pk_add_f32 v[54:55], v[54:55], v[186:187]
    v_pk_add_f32 v[56:57], v[56:57], v[188:189]
    v_pk_add_f32 v[58:59], v[58:59], v[190:191]
    v_pk_add_f32 v[20:21], v[20:21], v[52:53]
    v_pk_add_f32 v[22:23], v[22:23], v[54:55]
    v_pk_add_f32 v[24:25], v[24:25], v[56:57]
    v_pk_add_f32 v[26:27], v[26:27], v[58:59]
L_pub:
    v_and_or_b32 v20, v20, v205, s68
    v_and_or_b32 v21, v21, v205, s69
    v_and_or_b32 v22, v22, v205, s70
    v_and_or_b32 v23, v23, v205, s71
    buffer_store_dwordx4 v[20:23], v196, s[40:43], s16 offen sc1
    v_and_or_b32 v24, v24, v205, s68
    v_and_or_b32 v25, v25, v205, s69
    v_and_or_b32 v26, v26, v205, s70
    v_and_or_b32 v27, v27, v205, s71
    buffer_store_dwordx4 v[24:27], v196, s[40:43], s26 offen sc1
    s_cmp_ge_u32 s2, 224
    s_cbranch_scc1 L_sdone
    s_branch L_bwx
L_bw0:
    s_mov_b32 s59, 400000
L_bw:
    s_mov_b32 s54, 0
    s_atomic_add s54, s[24:25], 0 glc
    s_sub_u32 s59, s59, 1
    s_cbranch_scc1 L_bwx
    s_waitcnt lgkmcnt(0)
    s_cmp_lt_u32 s54, 32
    s_cbranch_scc1 L_bw
L_bwx:
    s_barrier
    buffer_load_dwordx4 v[64:67], v197, s[40:43], s17 offen sc1
    buffer_load_dwordx4 v[68:71], v197, s[40:43], s66 offen sc1
    buffer_load_dwordx4 v[72:75], v197, s[40:43], s65 offen sc1
    buffer_load_dwordx4 v[76:79], v197, s[40:43], s31 offen sc1
    s_mov_b32 s59, 400000
    s_mov_b32 s49, 0x41f80000
    s_cmp_eq_u32 s54, 3
    s_cbranch_scc1 L_fs
    s_waitcnt vmcnt(4)
L_fs:
    s_barrier
    ds_read_b64_tr_b16 v[144:145], v5 offset:51200
    ds_read_b64_tr_b16 v[146:147], v5 offset:53248
    ds_read_b64_tr_b16 v[148:149], v5 offset:55296
    ds_read_b64_tr_b16 v[150:151], v5 offset:57344
    ds_read_b64_tr_b16 v[128:129], v5 offset:34816
    ds_read_b64_tr_b16 v[130:131], v5 offset:36864
    ds_read_b64_tr_b16 v[132:133], v5 offset:38912
    ds_read_b64_tr_b16 v[134:135], v5 offset:40960
    ds_read_b64_tr_b16 v[136:137], v5 offset:43008
    ds_read_b64_tr_b16 v[138:139], v5 offset:45056
    ds_read_b64_tr_b16 v[140:141], v5 offset:47104
    ds_read_b64_tr_b16 v[142:143], v5 offset:49152
    s_waitcnt lgkmcnt(8)
    v_mfma_f32_16x16x32_bf16 v[104:107], v[164:167], v[144:147], 0
    v_mfma_f32_16x16x32_bf16 v[104:107], v[168:171], v[148:151], v[104:107]
    s_branch L_p1c
L_p1:
    s_mov_b64 exec, vcc
    buffer_load_dwordx4 v[64:67], v197, s[40:43], s17 offen sc1
    buffer_load_dwordx4 v[68:71], v197, s[40:43], s66 offen sc1
    buffer_load_dwordx4 v[72:75], v197, s[40:43], s65 offen sc1
    buffer_load_dwordx4 v[76:79], v197, s[40:43], s31 offen sc1
L_p1c:
    s_waitcnt vmcnt(0)
    v_xor_b32 v64, s68, v64
    v_xor_b32 v65, s69, v65
    v_xor_b32 v66, s70, v66
    v_xor_b32 v67, s71, v67
    v_xor_b32 v68, s68, v68
    v_xor_b32 v69, s69, v69
    v_xor_b32 v70, s70, v70
    v_xor_b32 v71, s71, v71
    v_xor_b32 v72, s68, v72
    v_xor_b32 v73, s69, v73
    v_xor_b32 v74, s70, v74
    v_xor_b32 v75, s71, v75
    v_xor_b32 v76, s68, v76
    v_xor_b32 v77, s69, v77
    v_xor_b32 v78, s70, v78
    v_xor_b32 v79, s71, v79
    v_or3_b32 v48, v64, v65, v66
    v_or3_b32 v49, v67, v68, v69
    v_or3_b32 v50, v70, v71, v72
    v_or3_b32 v51, v73, v74, v75
    v_or3_b32 v48, v48, v76, v77
    v_or3_b32 v49, v49, v78, v79
    v_or3_b32 v48, v48, v50, v51
    v_bitop3_b32 v48, v48, v49, v205 bitop3:0x54
    s_sub_u32 s59, s59, 1
    v_cmp_ne_u32 vcc, 0, v48
    s_cbranch_scc1 L_p1ok
    s_cbranch_vccnz L_p1
L_p1ok:
    s_mov_b64 exec, -1
    v_pk_add_f32 v[64:65], v[64:65], v[68:69]
    v_pk_add_f32 v[72:73], v[72:73], v[76:77]
    v_pk_add_f32 v[66:67], v[66:67], v[70:71]
    v_pk_add_f32 v[74:75], v[74:75], v[78:79]
    v_permlane32_swap_b32 v64, v72
    v_permlane32_swap_b32 v65, v73
    v_permlane32_swap_b32 v66, v74
    v_permlane32_swap_b32 v67, v75
    v_add_f32 v64, v64, v72
    v_add_f32 v66, v66, v74
    v_add_f32 v65, v65, v73
    v_add_f32 v67, v67, v75
    v_permlane16_swap_b32 v64, v66
    v_mul_f32 v104, v104, v163
    v_permlane16_swap_b32 v65, v67
    v_add_f32 v64, v64, v66
    v_add_f32 v65, v65, v67
    s_nop 0
    v_add_f32_dpp v64, v64, v64 row_ror:8 row_mask:0xf bank_mask:0xf
    v_add_f32_dpp v65, v65, v65 row_ror:8 row_mask:0xf bank_mask:0xf
    v_cvt_pk_bf16_f32 v64, v64, v65
    ds_write_b32 v200, v64 offset:26624
    s_waitcnt lgkmcnt(0)
    s_barrier
    ds_read_b128 v[80:83], v201 offset:26624
    ds_read_b128 v[84:87], v201 offset:26688
    ds_read_b128 v[88:91], v201 offset:26752
    ds_read_b128 v[92:95], v201 offset:26816
    s_waitcnt lgkmcnt(3)
    v_mfma_f32_16x16x32_bf16 v[96:99], v[80:83], v[128:131], 0
    s_waitcnt lgkmcnt(2)
    v_mfma_f32_16x16x32_bf16 v[100:103], v[84:87], v[132:135], 0
    s_waitcnt lgkmcnt(1)
    v_mfma_f32_16x16x32_bf16 v[96:99], v[88:91], v[136:139], v[96:99]
    s_waitcnt lgkmcnt(0)
    v_mfma_f32_16x16x32_bf16 v[100:103], v[92:95], v[140:143], v[100:103]
    s_mov_b32 exec_lo, 0xff8001ff
    s_mov_b32 exec_hi, 0xff8001ff
    s_nop 4
    v_fmac_f32 v104, v162, v96
    v_fmac_f32 v104, v162, v100
    v_cndmask_b32 v22, v104, 1.0, s[60:61]
    buffer_atomic_add_f32 v22, v202, s[40:43], s18 offen sc0 sc1
    s_waitcnt vmcnt(0)
    v_cmp_eq_f32 vcc, s49, v22
    v_add_f32 v20, v104, v22
    s_bfe_i32 s56, vcc_lo, 0x10008
    s_bfe_i32 s57, vcc_lo, 0x10017
    s_bfe_i32 s62, vcc_hi, 0x10008
    s_bfe_i32 s63, vcc_hi, 0x10017
    v_cvt_pk_bf16_f32 v20, v20, v20
    s_pack_ll_b32_b16 s54, s56, s57
    s_pack_ll_b32_b16 s55, s62, s63
    s_and_b32 exec_lo, s54, 0xff0000ff
    s_and_b32 exec_hi, s55, 0xff0000ff
    s_cbranch_execz L_sdone
    buffer_store_short v20, v203, s[20:23], s19 offen
L_sdone:
    s_endpgm
.fill (((gated_mix__gqa_block_cached__glu_gated_glu__decode_kernel - .) & 4095) >> 2), 4, 0xbf810000
L_tch1:
    s_branch L_tback
L_helper:
    v_lshrrev_b32 v1, 2, v3
    v_lshl_add_u32 v1, v2, 2, v1
    v_lshlrev_b32 v8, 7, v1
    v_and_b32 v6, 3, v3
    v_lshl_add_u32 v8, v6, 3, v8
    v_bfe_u32 v1, v1, 1, 2
    v_lshlrev_b32 v1, 5, v1
    v_add_u32 v8, v8, v1
    v_xor_b32 v9, 32, v8
    v_xor_b32 v10, 64, v8
    v_xor_b32 v11, 0x60, v8
    v_and_b32 v14, 1, v3
    v_mul_u32_u24 v6, 896, v14
    v_lshl_add_u32 v6, v2, 3, v6
    v_bfe_u32 v7, v3, 1, 2
    v_lshl_add_u32 v7, v7, 2, v2
    v_lshlrev_b32 v7, 4, v7
    v_mov_b32 v15, -4
    v_mov_b32 v30, 0
    v_and_b32 v1, 2, v3
    v_cmp_ne_u32 s[60:61], 0, v1
    v_and_b32 v1, 4, v3
    v_cmp_ne_u32 s[62:63], 0, v1
    s_lshl_b32 s57, s64, 13
    s_lshl_b32 s58, s31, 11
    s_add_u32 s57, s57, s58
    s_lshl_b32 s58, s30, 8
    s_add_u32 s57, s57, s58
    s_add_u32 s57, s57, 32768
    s_mul_i32 s44, s31, 224
    v_add_u32 v1, s44, v6
    v_lshl_add_u32 v104, v14, 16, v7
    s_mov_b32 s47, 0
    s_waitcnt lgkmcnt(0)
    s_add_u32 s46, s46, 0x01010101
    s_and_b32 s50, s46, 0xff
    s_bfe_u32 s51, s46, 0x80008
    s_bfe_u32 s52, s46, 0x80010
    s_lshr_b32 s53, s46, 24
    v_lshlrev_b32 v100, 3, v2
    v_lshrrev_b32 v100, v100, s46
    v_bfe_u32 v96, v100, 0, 2
    v_bfe_u32 v97, v100, 2, 2
    v_bfe_u32 v98, v100, 4, 2
    v_bfe_u32 v99, v100, 6, 2
    s_waitcnt vmcnt(2)
L_tile:
    ds_read_b64 v[16:17], v1 offset:0
    ds_read_b64_tr_b16 v[32:33], v8 offset:2048
    ds_read_b64_tr_b16 v[46:47], v9 offset:2048
    ds_read_b64_tr_b16 v[60:61], v10 offset:2048
    ds_read_b64_tr_b16 v[74:75], v11 offset:2048
    ds_read_b64 v[18:19], v1 offset:32
    ds_read_b64_tr_b16 v[34:35], v8 offset:4096
    ds_read_b64_tr_b16 v[48:49], v9 offset:4096
    ds_read_b64_tr_b16 v[62:63], v10 offset:4096
    ds_read_b64_tr_b16 v[76:77], v11 offset:4096
    ds_read_b64 v[20:21], v1 offset:64
    ds_read_b64_tr_b16 v[36:37], v8 offset:6144
    ds_read_b64_tr_b16 v[50:51], v9 offset:6144
    ds_read_b64_tr_b16 v[64:65], v10 offset:6144
    ds_read_b64_tr_b16 v[78:79], v11 offset:6144
    ds_read_b64 v[22:23], v1 offset:96
    ds_read_b64_tr_b16 v[38:39], v8 offset:8192
    ds_read_b64_tr_b16 v[52:53], v9 offset:8192
    ds_read_b64_tr_b16 v[66:67], v10 offset:8192
    ds_read_b64_tr_b16 v[80:81], v11 offset:8192
    ds_read_b64 v[24:25], v1 offset:128
    ds_read_b64_tr_b16 v[40:41], v8 offset:10240
    ds_read_b64_tr_b16 v[54:55], v9 offset:10240
    ds_read_b64_tr_b16 v[68:69], v10 offset:10240
    ds_read_b64_tr_b16 v[82:83], v11 offset:10240
    ds_read_b64 v[26:27], v1 offset:160
    ds_read_b64_tr_b16 v[42:43], v8 offset:12288
    ds_read_b64_tr_b16 v[56:57], v9 offset:12288
    ds_read_b64_tr_b16 v[70:71], v10 offset:12288
    ds_read_b64_tr_b16 v[84:85], v11 offset:12288
    ds_read_b64 v[28:29], v1 offset:192
    ds_read_b64_tr_b16 v[44:45], v8 offset:14336
    ds_read_b64_tr_b16 v[58:59], v9 offset:14336
    ds_read_b64_tr_b16 v[72:73], v10 offset:14336
    ds_read_b64_tr_b16 v[86:87], v11 offset:14336
    s_waitcnt lgkmcnt(0)
    v_mfma_f32_16x16x16_bf16 v[120:123], v[44:45], v[28:29], 0
    v_mfma_f32_16x16x16_bf16 v[124:127], v[58:59], v[28:29], 0
    v_mfma_f32_16x16x16_bf16 v[128:131], v[72:73], v[28:29], 0
    v_mfma_f32_16x16x16_bf16 v[132:135], v[86:87], v[28:29], 0
    s_nop 2
    v_mfma_f32_16x16x32_bf16 v[120:123], v[32:35], v[16:19], v[120:123]
    v_mfma_f32_16x16x32_bf16 v[124:127], v[46:49], v[16:19], v[124:127]
    v_mfma_f32_16x16x32_bf16 v[128:131], v[60:63], v[16:19], v[128:131]
    v_mfma_f32_16x16x32_bf16 v[132:135], v[74:77], v[16:19], v[132:135]
    v_mfma_f32_16x16x32_bf16 v[120:123], v[36:39], v[20:23], v[120:123]
    v_mfma_f32_16x16x32_bf16 v[124:127], v[50:53], v[20:23], v[124:127]
    v_mfma_f32_16x16x32_bf16 v[128:131], v[64:67], v[20:23], v[128:131]
    v_mfma_f32_16x16x32_bf16 v[132:135], v[78:81], v[20:23], v[132:135]
    v_mfma_f32_16x16x32_bf16 v[120:123], v[40:43], v[24:27], v[120:123]
    v_mfma_f32_16x16x32_bf16 v[124:127], v[54:57], v[24:27], v[124:127]
    v_mfma_f32_16x16x32_bf16 v[128:131], v[68:71], v[24:27], v[128:131]
    v_mfma_f32_16x16x32_bf16 v[132:135], v[82:85], v[24:27], v[132:135]
    s_nop 5
    v_cndmask_b32 v120, v120, v124, s[60:61]
    v_cndmask_b32 v121, v121, v125, s[60:61]
    v_cndmask_b32 v122, v122, v126, s[60:61]
    v_cndmask_b32 v123, v123, v127, s[60:61]
    v_cndmask_b32 v128, v128, v132, s[60:61]
    v_cndmask_b32 v129, v129, v133, s[60:61]
    v_cndmask_b32 v130, v130, v134, s[60:61]
    v_cndmask_b32 v131, v131, v135, s[60:61]
    v_cndmask_b32 v120, v120, v128, s[62:63]
    v_cndmask_b32 v121, v121, v129, s[62:63]
    v_cndmask_b32 v122, v122, v130, s[62:63]
    v_cndmask_b32 v123, v123, v131, s[62:63]
    v_and_or_b32 v120, v120, v15, v96
    v_and_or_b32 v121, v121, v15, v97
    v_and_or_b32 v122, v122, v15, v98
    v_and_or_b32 v123, v123, v15, v99
    s_mov_b32 exec_lo, 0x00ff00ff
    s_mov_b32 exec_hi, 0x00ff00ff
    buffer_store_dwordx4 v[120:123], v104, s[40:43], s57 offen sc1
    s_mov_b64 exec, -1
    s_cmp_eq_u32 s47, 1
    s_cbranch_scc1 L_tiledone
    s_waitcnt vmcnt(1)
    s_and_b32 s67, s2, 15
    s_lshr_b32 s56, s2, 4
    s_lshl_b32 s56, s56, 2
    s_and_b32 s57, s2, 3
    s_add_u32 s56, s56, s57
    s_mul_i32 s56, s56, 512
    s_add_u32 s56, s56, 458752
    s_cmp_lt_u32 s67, 4
    s_cbranch_scc1 L_z1
    s_add_u32 s56, s56, 256
    s_and_b32 s57, s2, 0x8c
    s_cmp_eq_u32 s57, 8
    s_cbranch_scc0 L_noz1
L_z1:
L_z2:
    s_mov_b64 exec, 1
    buffer_store_dword v30, v30, s[40:43], s56 offen sc1
    s_mov_b64 exec, -1
L_noz1:
    s_sub_u32 s44, s2, 32
    s_cmp_lt_u32 s44, 7
    s_cbranch_scc0 L_noz2
    v_lshrrev_b32 v1, 2, v0
    v_mul_u32_u24 v1, 128, v1
    v_and_b32 v31, 3, v0
    v_lshl_add_u32 v1, v31, 4, v1
    v_mov_b32 v32, 0
    v_mov_b32 v33, 0
    v_mov_b32 v34, 0
    v_mov_b32 v35, 0
    s_mul_i32 s56, s44, 2048
    s_add_u32 s56, s56, 327680
    buffer_store_dwordx4 v[32:35], v1, s[40:43], s56 offen sc1
    s_mov_b32 s32, s24
    s_mov_b32 s33, s25
    s_lshl_b32 s56, s44, 7
    v_mul_u32_u24 v1, 768, v13
    v_add_u32 v1, v1, v5
    s_mov_b64 exec, 0xffff
    buffer_store_dwordx4 v[32:35], v1, s[32:35], s56 offen sc1
    s_mov_b64 exec, -1
L_noz2:
    s_cmp_ge_u32 s67, 14
    s_cbranch_scc1 L_gate
    s_lshr_b32 s45, s2, 4
    s_mul_i32 s45, s45, 14
    s_add_u32 s55, s67, s45
    s_mul_i32 s54, s55, 2341
    s_lshr_b32 s54, s54, 16
    s_mul_i32 s45, s54, 28
    s_sub_u32 s55, s55, s45
    s_and_b32 s56, s54, 3
    s_mul_i32 s48, s56, 401408
    s_lshl_b32 s45, s55, 7
    s_add_u32 s48, s48, s45
    v_mul_u32_u24 v4, 3584, v13
    v_add_u32 v4, v4, v12
    s_cmp_ge_u32 s54, 4
    s_cselect_b32 s36, s18, s16
    s_cselect_b32 s37, s19, s17
    s_mov_b32 s38, 1605632
    s_mov_b32 m0, 2048
    s_nop 0
L_gdma:
    buffer_load_dwordx4 v4, s[36:39], s48 offen nt lds
    s_add_u32 m0, m0, 1024
    s_add_u32 s48, s48, 28672
    s_cmp_lt_u32 m0, 16384
    s_cbranch_scc1 L_gdma
    s_branch L_gate
L_tch2:
    s_branch L_tback
L_gate:
    v_lshrrev_b32 v1, 5, v0
    v_mul_u32_u24 v1, 896, v1
    v_add_u32 v1, v1, v107
    ds_read_b128 v[40:43], v1 offset:0
    ds_read_b128 v[44:47], v1 offset:16
    v_mov_b32 v116, 0
    s_mov_b32 exec_lo, 0x0fffffff
    s_mov_b32 exec_hi, 0x0fffffff
    s_waitcnt lgkmcnt(0)
    v_lshlrev_b32 v48, 16, v108
    v_and_b32 v49, 0xffff0000, v108
    v_lshlrev_b32 v50, 16, v40
    v_and_b32 v51, 0xffff0000, v40
    v_mul_f32 v48, v48, v50
    v_mul_f32 v49, v49, v51
    v_cvt_pk_bf16_f32 v48, v48, v49
    v_lshlrev_b32 v49, 16, v48
    v_and_b32 v48, 0xffff0000, v48
    v_add_f32 v116, v116, v49
    v_add_f32 v116, v116, v48
    v_lshlrev_b32 v48, 16, v109
    v_and_b32 v49, 0xffff0000, v109
    v_lshlrev_b32 v50, 16, v41
    v_and_b32 v51, 0xffff0000, v41
    v_mul_f32 v48, v48, v50
    v_mul_f32 v49, v49, v51
    v_cvt_pk_bf16_f32 v48, v48, v49
    v_lshlrev_b32 v49, 16, v48
    v_and_b32 v48, 0xffff0000, v48
    v_add_f32 v116, v116, v49
    v_add_f32 v116, v116, v48
    v_lshlrev_b32 v48, 16, v110
    v_and_b32 v49, 0xffff0000, v110
    v_lshlrev_b32 v50, 16, v42
    v_and_b32 v51, 0xffff0000, v42
    v_mul_f32 v48, v48, v50
    v_mul_f32 v49, v49, v51
    v_cvt_pk_bf16_f32 v48, v48, v49
    v_lshlrev_b32 v49, 16, v48
    v_and_b32 v48, 0xffff0000, v48
    v_add_f32 v116, v116, v49
    v_add_f32 v116, v116, v48
    v_lshlrev_b32 v48, 16, v111
    v_and_b32 v49, 0xffff0000, v111
    v_lshlrev_b32 v50, 16, v43
    v_and_b32 v51, 0xffff0000, v43
    v_mul_f32 v48, v48, v50
    v_mul_f32 v49, v49, v51
    v_cvt_pk_bf16_f32 v48, v48, v49
    v_lshlrev_b32 v49, 16, v48
    v_and_b32 v48, 0xffff0000, v48
    v_add_f32 v116, v116, v49
    v_add_f32 v116, v116, v48
    v_lshlrev_b32 v48, 16, v112
    v_and_b32 v49, 0xffff0000, v112
    v_lshlrev_b32 v50, 16, v44
    v_and_b32 v51, 0xffff0000, v44
    v_mul_f32 v48, v48, v50
    v_mul_f32 v49, v49, v51
    v_cvt_pk_bf16_f32 v48, v48, v49
    v_lshlrev_b32 v49, 16, v48
    v_and_b32 v48, 0xffff0000, v48
    v_add_f32 v116, v116, v49
    v_add_f32 v116, v116, v48
    v_lshlrev_b32 v48, 16, v113
    v_and_b32 v49, 0xffff0000, v113
    v_lshlrev_b32 v50, 16, v45
    v_and_b32 v51, 0xffff0000, v45
    v_mul_f32 v48, v48, v50
    v_mul_f32 v49, v49, v51
    v_cvt_pk_bf16_f32 v48, v48, v49
    v_lshlrev_b32 v49, 16, v48
    v_and_b32 v48, 0xffff0000, v48
    v_add_f32 v116, v116, v49
    v_add_f32 v116, v116, v48
    v_lshlrev_b32 v48, 16, v114
    v_and_b32 v49, 0xffff0000, v114
    v_lshlrev_b32 v50, 16, v46
    v_and_b32 v51, 0xffff0000, v46
    v_mul_f32 v48, v48, v50
    v_mul_f32 v49, v49, v51
    v_cvt_pk_bf16_f32 v48, v48, v49
    v_lshlrev_b32 v49, 16, v48
    v_and_b32 v48, 0xffff0000, v48
    v_add_f32 v116, v116, v49
    v_add_f32 v116, v116, v48
    v_lshlrev_b32 v48, 16, v115
    v_and_b32 v49, 0xffff0000, v115
    v_lshlrev_b32 v50, 16, v47
    v_and_b32 v51, 0xffff0000, v47
    v_mul_f32 v48, v48, v50
    v_mul_f32 v49, v49, v51
    v_cvt_pk_bf16_f32 v48, v48, v49
    v_lshlrev_b32 v49, 16, v48
    v_and_b32 v48, 0xffff0000, v48
    v_add_f32 v116, v116, v49
    v_add_f32 v116, v116, v48
    s_mov_b64 exec, -1
    s_nop 1
    v_add_f32_dpp v116, v116, v116 quad_perm:[1,0,3,2] row_mask:0xf bank_mask:0xf
    s_nop 1
    v_add_f32_dpp v116, v116, v116 quad_perm:[2,3,0,1] row_mask:0xf bank_mask:0xf
    s_nop 1
    v_add_f32_dpp v116, v116, v116 row_half_mirror row_mask:0xf bank_mask:0xf
    s_nop 1
    v_add_f32_dpp v116, v116, v116 row_mirror row_mask:0xf bank_mask:0xf
    v_mov_b32 v48, v116
    s_nop 1
    v_permlane16_swap_b32 v116, v48
    v_add_f32 v116, v116, v48
    v_cvt_pk_bf16_f32 v116, v116, v116
    v_and_b32 v116, 0xffff0000, v116
    v_mul_f32 v116, 0xbfb8aa3b, v116
    v_exp_f32 v116, v116
    s_nop 0
    v_add_f32 v116, 1.0, v116
    v_rcp_f32 v116, v116
    s_nop 0
    v_cvt_pk_bf16_f32 v116, v116, v116
    v_and_b32 v116, 0xffff0000, v116
    v_sub_f32 v117, 1.0, v116
    v_cvt_pk_bf16_f32 v117, v117, v117
    v_and_b32 v117, 0xffff0000, v117
    v_lshrrev_b32 v1, 2, v0
    s_mov_b32 exec_lo, 1
    s_mov_b32 exec_hi, 1
    ds_write_b64 v1, v[116:117] offset:17536
    s_mov_b64 exec, -1
    s_waitcnt vmcnt(0)
    s_cmp_ge_u32 s67, 14
    s_cbranch_scc1 L_tiledone
    s_mov_b32 s47, 1
    s_mul_i32 s57, s54, 14336
    s_lshl_b32 s44, s55, 8
    s_add_u32 s57, s57, s44
    s_add_u32 s57, s57, 196608
    s_mul_i32 s44, s56, 224
    v_add_u32 v1, s44, v6
    v_mul_u32_u24 v104, 7168, v14
    v_add_u32 v104, v104, v7
    v_mov_b32 v15, 0xffffff00
    v_mov_b32 v96, s50
    v_mov_b32 v97, s51
    v_mov_b32 v98, s52
    v_mov_b32 v99, s53
    s_branch L_tile
L_tiledone:
    s_lshr_b32 s58, s2, 4
    s_lshl_b32 s58, s58, 13
    s_add_u32 s58, s58, 32768
    v_add_u32 v105, 0x1000, v5
    s_mov_b32 s59, 400000
L_qpoll:
    buffer_load_dwordx4 v[32:35], v5, s[40:43], s58 offen offset:0 sc1
    buffer_load_dwordx4 v[36:39], v5, s[40:43], s58 offen offset:1024 sc1
    buffer_load_dwordx4 v[40:43], v5, s[40:43], s58 offen offset:2048 sc1
    buffer_load_dwordx4 v[44:47], v5, s[40:43], s58 offen offset:3072 sc1
    buffer_load_dwordx4 v[48:51], v105, s[40:43], s58 offen offset:0 sc1
    buffer_load_dwordx4 v[52:55], v105, s[40:43], s58 offen offset:1024 sc1
    buffer_load_dwordx4 v[56:59], v105, s[40:43], s58 offen offset:2048 sc1
    buffer_load_dwordx4 v[60:63], v105, s[40:43], s58 offen offset:3072 sc1
    v_and_b32 v100, 3, v0
    v_lshlrev_b32 v100, 3, v100
    v_lshrrev_b32 v100, v100, s46
    v_bfe_u32 v96, v100, 0, 2
    v_bfe_u32 v97, v100, 2, 2
    v_bfe_u32 v98, v100, 4, 2
    v_bfe_u32 v99, v100, 6, 2
    s_waitcnt vmcnt(0)
    v_xor_b32 v32, v96, v32
    v_xor_b32 v33, v97, v33
    v_xor_b32 v34, v98, v34
    v_xor_b32 v35, v99, v35
    v_xor_b32 v36, v96, v36
    v_xor_b32 v37, v97, v37
    v_xor_b32 v38, v98, v38
    v_xor_b32 v39, v99, v39
    v_xor_b32 v40, v96, v40
    v_xor_b32 v41, v97, v41
    v_xor_b32 v42, v98, v42
    v_xor_b32 v43, v99, v43
    v_xor_b32 v44, v96, v44
    v_xor_b32 v45, v97, v45
    v_xor_b32 v46, v98, v46
    v_xor_b32 v47, v99, v47
    v_xor_b32 v48, v96, v48
    v_xor_b32 v49, v97, v49
    v_xor_b32 v50, v98, v50
    v_xor_b32 v51, v99, v51
    v_xor_b32 v52, v96, v52
    v_xor_b32 v53, v97, v53
    v_xor_b32 v54, v98, v54
    v_xor_b32 v55, v99, v55
    v_xor_b32 v56, v96, v56
    v_xor_b32 v57, v97, v57
    v_xor_b32 v58, v98, v58
    v_xor_b32 v59, v99, v59
    v_xor_b32 v60, v96, v60
    v_xor_b32 v61, v97, v61
    v_xor_b32 v62, v98, v62
    v_xor_b32 v63, v99, v63
    v_or3_b32 v1, v32, v33, v34
    v_or3_b32 v1, v1, v35, v36
    v_or3_b32 v1, v1, v37, v38
    v_or3_b32 v1, v1, v39, v40
    v_or3_b32 v1, v1, v41, v42
    v_or3_b32 v1, v1, v43, v44
    v_or3_b32 v1, v1, v45, v46
    v_or3_b32 v1, v1, v47, v48
    v_or3_b32 v1, v1, v49, v50
    v_or3_b32 v1, v1, v51, v52
    v_or3_b32 v1, v1, v53, v54
    v_or3_b32 v1, v1, v55, v56
    v_or3_b32 v1, v1, v57, v58
    v_or3_b32 v1, v1, v59, v60
    v_or3_b32 v1, v1, v61, v62
    v_or_b32 v1, v1, v63
    v_and_b32 v1, 3, v1
    v_cmp_ne_u32 vcc, 0, v1
    s_sub_u32 s59, s59, 1
    s_cbranch_scc1 L_qok
    s_cbranch_vccnz L_qpoll
L_qok:
    v_add_f32 v32, v32, v40
    v_add_f32 v33, v33, v41
    v_add_f32 v34, v34, v42
    v_add_f32 v35, v35, v43
    v_add_f32 v36, v36, v44
    v_add_f32 v37, v37, v45
    v_add_f32 v38, v38, v46
    v_add_f32 v39, v39, v47
    v_add_f32 v48, v48, v56
    v_add_f32 v49, v49, v57
    v_add_f32 v50, v50, v58
    v_add_f32 v51, v51, v59
    v_add_f32 v52, v52, v60
    v_add_f32 v53, v53, v61
    v_add_f32 v54, v54, v62
    v_add_f32 v55, v55, v63
    v_add_f32 v32, v32, v48
    v_add_f32 v33, v33, v49
    v_add_f32 v34, v34, v50
    v_add_f32 v35, v35, v51
    v_add_f32 v36, v36, v52
    v_add_f32 v37, v37, v53
    v_add_f32 v38, v38, v54
    v_add_f32 v39, v39, v55
    v_cvt_pk_bf16_f32 v32, v32, v33
    v_cvt_pk_bf16_f32 v33, v34, v35
    v_cvt_pk_bf16_f32 v34, v36, v37
    v_cvt_pk_bf16_f32 v35, v38, v39
    v_lshlrev_b32 v1, 3, v0
    v_mov_b32 v37, 1
    ds_write_b64 v1, v[32:33] offset:16384
    ds_write_b64 v1, v[34:35] offset:16896
    s_waitcnt lgkmcnt(0)
    ds_write_b32 v30, v37 offset:17408
    s_branch L_tch5
L_tch9:
    s_lshr_b32 s45, s2, 4
    s_lshl_b32 s45, s45, 14
    s_add_u32 s45, s45, 1048576
    s_bfe_u32 s48, s2, 0x30000
    s_lshl_b32 s48, s48, 11
    s_add_u32 s45, s45, s48
    s_bfe_u32 s48, s2, 0x10003
    s_lshl_b32 s48, s48, 8
    s_add_u32 s45, s45, s48
    v_and_b32 v4, 3, v0
    v_lshlrev_b32 v4, 4, v4
    v_bfe_u32 v1, v0, 2, 1
    v_lshl_add_u32 v4, v1, 6, v4
    v_bfe_u32 v1, v0, 3, 1
    v_lshl_add_u32 v4, v1, 7, v4
    v_bfe_u32 v1, v0, 4, 1
    v_lshl_add_u32 v4, v1, 9, v4
    v_bfe_u32 v1, v0, 5, 1
    v_lshl_add_u32 v4, v1, 10, v4
    s_mov_b32 s59, 400000
L_kw:
    s_sleep 16
    ds_read_b32 v31, v30 offset:17416
    s_sub_u32 s59, s59, 1
    s_cbranch_scc1 L_kwx
    s_waitcnt lgkmcnt(0)
    v_cmp_gt_u32 vcc, 4, v31
    s_cbranch_vccnz L_kw
L_kwx:
    ds_read_b128 v[80:83], v5 offset:30720
    ds_read_b128 v[84:87], v5 offset:31744
    ds_read_b128 v[88:91], v5 offset:32768
    ds_read_b128 v[92:95], v5 offset:33792
    s_mov_b32 s47, 0x3db8aa3b
    s_mov_b32 exec_lo, 0xffffffff
    s_mov_b32 exec_hi, 0x0
    s_waitcnt lgkmcnt(0)
    buffer_store_dwordx4 v[80:83], v4, s[40:43], s45 offen sc1
    s_mov_b64 exec, -1
    v_lshlrev_b32 v48, 16, v80
    v_and_b32 v49, 0xffff0000, v80
    v_lshlrev_b32 v50, 16, v81
    v_and_b32 v51, 0xffff0000, v81
    v_lshlrev_b32 v64, 16, v82
    v_and_b32 v65, 0xffff0000, v82
    v_lshlrev_b32 v66, 16, v83
    v_and_b32 v67, 0xffff0000, v83
    v_lshlrev_b32 v52, 16, v84
    v_and_b32 v53, 0xffff0000, v84
    v_lshlrev_b32 v54, 16, v85
    v_and_b32 v55, 0xffff0000, v85
    v_lshlrev_b32 v68, 16, v86
    v_and_b32 v69, 0xffff0000, v86
    v_lshlrev_b32 v70, 16, v87
    v_and_b32 v71, 0xffff0000, v87
    v_lshlrev_b32 v56, 16, v88
    v_and_b32 v57, 0xffff0000, v88
    v_lshlrev_b32 v58, 16, v89
    v_and_b32 v59, 0xffff0000, v89
    v_lshlrev_b32 v72, 16, v90
    v_and_b32 v73, 0xffff0000, v90
    v_lshlrev_b32 v74, 16, v91
    v_and_b32 v75, 0xffff0000, v91
    v_lshlrev_b32 v60, 16, v92
    v_and_b32 v61, 0xffff0000, v92
    v_lshlrev_b32 v62, 16, v93
    v_and_b32 v63, 0xffff0000, v93
    v_lshlrev_b32 v76, 16, v94
    v_and_b32 v77, 0xffff0000, v94
    v_lshlrev_b32 v78, 16, v95
    v_and_b32 v79, 0xffff0000, v95
    v_max3_f32 v32, v48, v49, v50
    v_max3_f32 v32, v32, v51, v52
    v_max3_f32 v32, v32, v53, v54
    v_max3_f32 v32, v32, v55, v56
    v_max3_f32 v32, v32, v57, v58
    v_max3_f32 v32, v32, v59, v60
    v_max3_f32 v32, v32, v61, v62
    v_max_f32 v32, v32, v63
    v_max3_f32 v33, v64, v65, v66
    v_max3_f32 v33, v33, v67, v68
    v_max3_f32 v33, v33, v69, v70
    v_max3_f32 v33, v33, v71, v72
    v_max3_f32 v33, v33, v73, v74
    v_max3_f32 v33, v33, v75, v76
    v_max3_f32 v33, v33, v77, v78
    v_max_f32 v33, v33, v79
    s_nop 0
    v_max_f32_dpp v32, v32, v32 quad_perm:[1,0,3,2] row_mask:0xf bank_mask:0xf
    v_max_f32_dpp v33, v33, v33 quad_perm:[1,0,3,2] row_mask:0xf bank_mask:0xf
    s_nop 0
    v_max_f32_dpp v32, v32, v32 quad_perm:[2,3,0,1] row_mask:0xf bank_mask:0xf
    v_max_f32_dpp v33, v33, v33 quad_perm:[2,3,0,1] row_mask:0xf bank_mask:0xf
    s_nop 0
    v_max_f32_dpp v32, v32, v32 row_half_mirror row_mask:0xf bank_mask:0xf
    v_max_f32_dpp v33, v33, v33 row_half_mirror row_mask:0xf bank_mask:0xf
    s_nop 0
    v_max_f32_dpp v32, v32, v32 row_mirror row_mask:0xf bank_mask:0xf
    v_max_f32_dpp v33, v33, v33 row_mirror row_mask:0xf bank_mask:0xf
    v_mov_b32 v34, v32
    v_mov_b32 v35, v33
    s_nop 1
    v_permlane16_swap_b32 v32, v34
    v_permlane16_swap_b32 v33, v35
    v_max_f32 v32, v32, v34
    v_max_f32 v33, v33, v35
    v_mov_b32 v34, v32
    v_mov_b32 v35, v33
    s_nop 1
    v_permlane32_swap_b32 v32, v34
    v_permlane32_swap_b32 v33, v35
    v_max_f32 v32, v32, v34
    v_max_f32 v33, v33, v35
    v_mul_f32 v32, s47, v32
    v_mul_f32 v33, s47, v33
    v_fma_f32 v48, v48, s47, -v32
    v_fma_f32 v49, v49, s47, -v32
    v_fma_f32 v50, v50, s47, -v32
    v_fma_f32 v51, v51, s47, -v32
    v_fma_f32 v52, v52, s47, -v32
    v_fma_f32 v53, v53, s47, -v32
    v_fma_f32 v54, v54, s47, -v32
    v_fma_f32 v55, v55, s47, -v32
    v_fma_f32 v56, v56, s47, -v32
    v_fma_f32 v57, v57, s47, -v32
    v_fma_f32 v58, v58, s47, -v32
    v_fma_f32 v59, v59, s47, -v32
    v_fma_f32 v60, v60, s47, -v32
    v_fma_f32 v61, v61, s47, -v32
    v_fma_f32 v62, v62, s47, -v32
    v_fma_f32 v63, v63, s47, -v32
    v_fma_f32 v64, v64, s47, -v33
    v_fma_f32 v65, v65, s47, -v33
    v_fma_f32 v66, v66, s47, -v33
    v_fma_f32 v67, v67, s47, -v33
    v_fma_f32 v68, v68, s47, -v33
    v_fma_f32 v69, v69, s47, -v33
    v_fma_f32 v70, v70, s47, -v33
    v_fma_f32 v71, v71, s47, -v33
    v_fma_f32 v72, v72, s47, -v33
    v_fma_f32 v73, v73, s47, -v33
    v_fma_f32 v74, v74, s47, -v33
    v_fma_f32 v75, v75, s47, -v33
    v_fma_f32 v76, v76, s47, -v33
    v_fma_f32 v77, v77, s47, -v33
    v_fma_f32 v78, v78, s47, -v33
    v_fma_f32 v79, v79, s47, -v33
    v_exp_f32 v48, v48
    v_exp_f32 v49, v49
    v_exp_f32 v50, v50
    v_exp_f32 v51, v51
    v_exp_f32 v52, v52
    v_exp_f32 v53, v53
    v_exp_f32 v54, v54
    v_exp_f32 v55, v55
    v_exp_f32 v56, v56
    v_exp_f32 v57, v57
    v_exp_f32 v58, v58
    v_exp_f32 v59, v59
    v_exp_f32 v60, v60
    v_exp_f32 v61, v61
    v_exp_f32 v62, v62
    v_exp_f32 v63, v63
    v_exp_f32 v64, v64
    v_exp_f32 v65, v65
    v_exp_f32 v66, v66
    v_exp_f32 v67, v67
    v_exp_f32 v68, v68
    v_exp_f32 v69, v69
    v_exp_f32 v70, v70
    v_exp_f32 v71, v71
    v_exp_f32 v72, v72
    v_exp_f32 v73, v73
    v_exp_f32 v74, v74
    v_exp_f32 v75, v75
    v_exp_f32 v76, v76
    v_exp_f32 v77, v77
    v_exp_f32 v78, v78
    v_exp_f32 v79, v79
    v_add_f32 v36, v48, v49
    v_add_f32 v37, v64, v65
    v_add_f32 v36, v36, v50
    v_add_f32 v37, v37, v66
    v_add_f32 v36, v36, v51
    v_add_f32 v37, v37, v67
    v_add_f32 v36, v36, v52
    v_add_f32 v37, v37, v68
    v_add_f32 v36, v36, v53
    v_add_f32 v37, v37, v69
    v_add_f32 v36, v36, v54
    v_add_f32 v37, v37, v70
    v_add_f32 v36, v36, v55
    v_add_f32 v37, v37, v71
    v_add_f32 v36, v36, v56
    v_add_f32 v37, v37, v72
    v_add_f32 v36, v36, v57
    v_add_f32 v37, v37, v73
    v_add_f32 v36, v36, v58
    v_add_f32 v37, v37, v74
    v_add_f32 v36, v36, v59
    v_add_f32 v37, v37, v75
    v_add_f32 v36, v36, v60
    v_add_f32 v37, v37, v76
    v_add_f32 v36, v36, v61
    v_add_f32 v37, v37, v77
    v_add_f32 v36, v36, v62
    v_add_f32 v37, v37, v78
    v_add_f32 v36, v36, v63
    v_add_f32 v37, v37, v79
    s_nop 0
    v_add_f32_dpp v36, v36, v36 quad_perm:[1,0,3,2] row_mask:0xf bank_mask:0xf
    v_add_f32_dpp v37, v37, v37 quad_perm:[1,0,3,2] row_mask:0xf bank_mask:0xf
    s_nop 0
    v_add_f32_dpp v36, v36, v36 quad_perm:[2,3,0,1] row_mask:0xf bank_mask:0xf
    v_add_f32_dpp v37, v37, v37 quad_perm:[2,3,0,1] row_mask:0xf bank_mask:0xf
    s_nop 0
    v_add_f32_dpp v36, v36, v36 row_half_mirror row_mask:0xf bank_mask:0xf
    v_add_f32_dpp v37, v37, v37 row_half_mirror row_mask:0xf bank_mask:0xf
    s_nop 0
    v_add_f32_dpp v36, v36, v36 row_mirror row_mask:0xf bank_mask:0xf
    v_add_f32_dpp v37, v37, v37 row_mirror row_mask:0xf bank_mask:0xf
    v_mov_b32 v38, v36
    v_mov_b32 v39, v37
    s_nop 1
    v_permlane16_swap_b32 v36, v38
    v_permlane16_swap_b32 v37, v39
    v_add_f32 v36, v36, v38
    v_add_f32 v37, v37, v39
    v_mov_b32 v38, v36
    v_mov_b32 v39, v37
    s_nop 1
    v_permlane32_swap_b32 v36, v38
    v_permlane32_swap_b32 v37, v39
    v_add_f32 v36, v36, v38
    v_add_f32 v37, v37, v39
    v_log_f32 v36, v36
    v_log_f32 v37, v37
    v_mov_b32 v35, s46
    v_add_f32 v32, v32, v36
    v_add_f32 v34, v33, v37
    v_mov_b32 v33, s46
    s_lshl_b32 s44, s2, 4
    s_add_u32 s44, s44, 397312
    s_mov_b64 exec, 1
    s_waitcnt vmcnt(0)
    buffer_store_dwordx4 v[32:35], v5, s[40:43], s44 offen sc1
    s_mov_b64 exec, -1
    s_and_b32 s44, s44, 0xfffff700
    s_lshr_b32 s45, s2, 7
    v_xor_b32 v6, s45, v2
    v_and_b32 v6, 1, v6
    v_lshlrev_b32 v6, 11, v6
    v_lshl_add_u32 v6, v3, 4, v6
    v_and_b32 v1, 3, v0
    v_lshlrev_b32 v1, 1, v1
    v_bfe_u32 v14, v0, 2, 1
    v_add_u32 v1, v1, v14
    v_mul_u32_u24 v4, 7168, v1
    v_lshl_add_u32 v4, v13, 4, v4
    v_add_u32 v7, 128, v4
    s_lshr_b32 s55, s2, 3
    s_min_u32 s55, s55, 27
    s_mul_i32 s54, s55, 37
    s_lshr_b32 s54, s54, 8
    s_mul_i32 s48, s54, 7
    s_sub_u32 s55, s55, s48
    s_and_b32 s48, s2, 7
    s_lshl_b32 s48, s48, 2
    s_add_u32 s54, s54, s48
    s_mul_i32 s45, s54, 224
    s_lshl_b32 s47, s55, 8
    s_add_u32 s47, s47, 14336
    s_sub_u32 s47, s47, s45
    s_mov_b32 exec_lo, 0
    s_mov_b32 exec_hi, 0xffff0000
    v_mov_b32 v7, s47
    s_mov_b64 exec, -1
    s_add_u32 s45, s45, 196608
    s_add_u32 s47, s45, 57344
    s_mov_b32 s59, 400000
L_tw:
    s_sleep 16
    ds_read_b32 v31, v30 offset:17428
    s_sub_u32 s59, s59, 1
    s_cbranch_scc1 L_twx
    s_waitcnt lgkmcnt(0)
    v_cmp_gt_u32 vcc, 1, v31
    s_cbranch_vccnz L_tw
L_twx:
    s_mov_b32 s59, 400000
    s_branch L_lp1
L_lp:
    s_sleep 16
L_lp1:
    buffer_load_dwordx4 v[40:43], v6, s[40:43], s44 offen sc1
    buffer_load_dwordx4 v[64:67], v4, s[40:43], s45 offen sc1
    buffer_load_dwordx4 v[68:71], v7, s[40:43], s45 offen sc1
    buffer_load_dwordx4 v[72:75], v4, s[40:43], s47 offen sc1
    buffer_load_dwordx4 v[76:79], v7, s[40:43], s47 offen sc1
    s_waitcnt vmcnt(0)
    v_xor_b32 v64, s50, v64
    v_xor_b32 v65, s51, v65
    v_xor_b32 v66, s52, v66
    v_xor_b32 v67, s53, v67
    v_xor_b32 v68, s50, v68
    v_xor_b32 v69, s51, v69
    v_xor_b32 v70, s52, v70
    v_xor_b32 v71, s53, v71
    v_xor_b32 v72, s50, v72
    v_xor_b32 v73, s51, v73
    v_xor_b32 v74, s52, v74
    v_xor_b32 v75, s53, v75
    v_xor_b32 v76, s50, v76
    v_xor_b32 v77, s51, v77
    v_xor_b32 v78, s52, v78
    v_xor_b32 v79, s53, v79
    v_or3_b32 v1, v64, v65, v66
    v_or3_b32 v1, v1, v67, v68
    v_or3_b32 v1, v1, v69, v70
    v_or3_b32 v1, v1, v71, v72
    v_or3_b32 v1, v1, v73, v74
    v_or3_b32 v1, v1, v75, v76
    v_or3_b32 v1, v1, v77, v78
    v_or_b32 v1, v1, v79
    v_and_b32 v1, 255, v1
    v_xor_b32 v41, s46, v41
    v_xor_b32 v43, s46, v43
    v_or3_b32 v1, v1, v41, v43
    s_sub_u32 s59, s59, 1
    v_cmp_ne_u32 vcc, 0, v1
    s_cbranch_scc1 L_lpok
    s_cbranch_vccnz L_lp
L_lpok:
    v_add_f32_dpp v64, v64, v64 quad_perm:[1,0,3,2] row_mask:0xf bank_mask:0xf
    v_add_f32_dpp v65, v65, v65 quad_perm:[1,0,3,2] row_mask:0xf bank_mask:0xf
    v_add_f32_dpp v66, v66, v66 quad_perm:[1,0,3,2] row_mask:0xf bank_mask:0xf
    v_add_f32_dpp v67, v67, v67 quad_perm:[1,0,3,2] row_mask:0xf bank_mask:0xf
    v_add_f32_dpp v68, v68, v68 quad_perm:[1,0,3,2] row_mask:0xf bank_mask:0xf
    v_add_f32_dpp v69, v69, v69 quad_perm:[1,0,3,2] row_mask:0xf bank_mask:0xf
    v_add_f32_dpp v70, v70, v70 quad_perm:[1,0,3,2] row_mask:0xf bank_mask:0xf
    v_add_f32_dpp v71, v71, v71 quad_perm:[1,0,3,2] row_mask:0xf bank_mask:0xf
    v_add_f32_dpp v72, v72, v72 quad_perm:[1,0,3,2] row_mask:0xf bank_mask:0xf
    v_add_f32_dpp v73, v73, v73 quad_perm:[1,0,3,2] row_mask:0xf bank_mask:0xf
    v_add_f32_dpp v74, v74, v74 quad_perm:[1,0,3,2] row_mask:0xf bank_mask:0xf
    v_add_f32_dpp v75, v75, v75 quad_perm:[1,0,3,2] row_mask:0xf bank_mask:0xf
    v_add_f32_dpp v76, v76, v76 quad_perm:[1,0,3,2] row_mask:0xf bank_mask:0xf
    v_add_f32_dpp v77, v77, v77 quad_perm:[1,0,3,2] row_mask:0xf bank_mask:0xf
    v_add_f32_dpp v78, v78, v78 quad_perm:[1,0,3,2] row_mask:0xf bank_mask:0xf
    v_add_f32_dpp v79, v79, v79 quad_perm:[1,0,3,2] row_mask:0xf bank_mask:0xf
    v_add_f32_dpp v64, v64, v64 quad_perm:[2,3,0,1] row_mask:0xf bank_mask:0xf
    v_add_f32_dpp v65, v65, v65 quad_perm:[2,3,0,1] row_mask:0xf bank_mask:0xf
    v_add_f32_dpp v66, v66, v66 quad_perm:[2,3,0,1] row_mask:0xf bank_mask:0xf
    v_add_f32_dpp v67, v67, v67 quad_perm:[2,3,0,1] row_mask:0xf bank_mask:0xf
    v_add_f32_dpp v68, v68, v68 quad_perm:[2,3,0,1] row_mask:0xf bank_mask:0xf
    v_add_f32_dpp v69, v69, v69 quad_perm:[2,3,0,1] row_mask:0xf bank_mask:0xf
    v_add_f32_dpp v70, v70, v70 quad_perm:[2,3,0,1] row_mask:0xf bank_mask:0xf
    v_add_f32_dpp v71, v71, v71 quad_perm:[2,3,0,1] row_mask:0xf bank_mask:0xf
    v_add_f32_dpp v72, v72, v72 quad_perm:[2,3,0,1] row_mask:0xf bank_mask:0xf
    v_add_f32_dpp v73, v73, v73 quad_perm:[2,3,0,1] row_mask:0xf bank_mask:0xf
    v_add_f32_dpp v74, v74, v74 quad_perm:[2,3,0,1] row_mask:0xf bank_mask:0xf
    v_add_f32_dpp v75, v75, v75 quad_perm:[2,3,0,1] row_mask:0xf bank_mask:0xf
    v_add_f32_dpp v76, v76, v76 quad_perm:[2,3,0,1] row_mask:0xf bank_mask:0xf
    v_add_f32_dpp v77, v77, v77 quad_perm:[2,3,0,1] row_mask:0xf bank_mask:0xf
    v_add_f32_dpp v78, v78, v78 quad_perm:[2,3,0,1] row_mask:0xf bank_mask:0xf
    v_add_f32_dpp v79, v79, v79 quad_perm:[2,3,0,1] row_mask:0xf bank_mask:0xf
    v_cvt_pk_bf16_f32 v72, v64, v72
    v_cvt_pk_bf16_f32 v73, v65, v73
    v_cvt_pk_bf16_f32 v74, v66, v74
    v_cvt_pk_bf16_f32 v75, v67, v75
    v_cvt_pk_bf16_f32 v76, v68, v76
    v_cvt_pk_bf16_f32 v77, v69, v77
    v_cvt_pk_bf16_f32 v78, v70, v78
    v_cvt_pk_bf16_f32 v79, v71, v79
    v_lshlrev_b32 v64, 16, v72
    v_lshlrev_b32 v65, 16, v73
    v_lshlrev_b32 v66, 16, v74
    v_lshlrev_b32 v67, 16, v75
    v_lshlrev_b32 v68, 16, v76
    v_lshlrev_b32 v69, 16, v77
    v_lshlrev_b32 v70, 16, v78
    v_lshlrev_b32 v71, 16, v79
    v_and_b32 v72, 0xffff0000, v72
    v_and_b32 v73, 0xffff0000, v73
    v_and_b32 v74, 0xffff0000, v74
    v_and_b32 v75, 0xffff0000, v75
    v_and_b32 v76, 0xffff0000, v76
    v_and_b32 v77, 0xffff0000, v77
    v_and_b32 v78, 0xffff0000, v78
    v_and_b32 v79, 0xffff0000, v79
    v_mul_f32 v64, 0xbfb8aa3b, v64
    v_mul_f32 v65, 0xbfb8aa3b, v65
    v_mul_f32 v66, 0xbfb8aa3b, v66
    v_mul_f32 v67, 0xbfb8aa3b, v67
    v_mul_f32 v68, 0xbfb8aa3b, v68
    v_mul_f32 v69, 0xbfb8aa3b, v69
    v_mul_f32 v70, 0xbfb8aa3b, v70
    v_mul_f32 v71, 0xbfb8aa3b, v71
    v_exp_f32 v64, v64
    v_exp_f32 v65, v65
    v_exp_f32 v66, v66
    v_exp_f32 v67, v67
    v_exp_f32 v68, v68
    v_exp_f32 v69, v69
    v_exp_f32 v70, v70
    v_exp_f32 v71, v71
    v_add_f32 v64, 1.0, v64
    v_add_f32 v65, 1.0, v65
    v_add_f32 v66, 1.0, v66
    v_add_f32 v67, 1.0, v67
    v_add_f32 v68, 1.0, v68
    v_add_f32 v69, 1.0, v69
    v_add_f32 v70, 1.0, v70
    v_add_f32 v71, 1.0, v71
    v_rcp_f32 v64, v64
    v_rcp_f32 v65, v65
    v_rcp_f32 v66, v66
    v_rcp_f32 v67, v67
    v_rcp_f32 v68, v68
    v_rcp_f32 v69, v69
    v_rcp_f32 v70, v70
    v_rcp_f32 v71, v71
    v_cvt_pk_bf16_f32 v64, v64, v64
    v_cvt_pk_bf16_f32 v65, v65, v65
    v_cvt_pk_bf16_f32 v66, v66, v66
    v_cvt_pk_bf16_f32 v67, v67, v67
    v_cvt_pk_bf16_f32 v68, v68, v68
    v_cvt_pk_bf16_f32 v69, v69, v69
    v_cvt_pk_bf16_f32 v70, v70, v70
    v_cvt_pk_bf16_f32 v71, v71, v71
    v_and_b32 v64, 0xffff0000, v64
    v_and_b32 v65, 0xffff0000, v65
    v_and_b32 v66, 0xffff0000, v66
    v_and_b32 v67, 0xffff0000, v67
    v_and_b32 v68, 0xffff0000, v68
    v_and_b32 v69, 0xffff0000, v69
    v_and_b32 v70, 0xffff0000, v70
    v_and_b32 v71, 0xffff0000, v71
    v_mul_f32 v64, v64, v72
    v_mul_f32 v65, v65, v73
    v_mul_f32 v66, v66, v74
    v_mul_f32 v67, v67, v75
    v_mul_f32 v68, v68, v76
    v_mul_f32 v69, v69, v77
    v_mul_f32 v70, v70, v78
    v_mul_f32 v71, v71, v79
    v_cvt_pk_bf16_f32 v64, v64, v65
    v_cvt_pk_bf16_f32 v65, v66, v67
    v_cvt_pk_bf16_f32 v66, v68, v69
    v_cvt_pk_bf16_f32 v67, v70, v71
    v_lshlrev_b32 v1, 7, v14
    v_lshl_add_u32 v1, v13, 3, v1
    s_mov_b32 exec_lo, 0
    s_mov_b32 exec_hi, 0xffff0000
    v_mov_b32 v66, 0
    v_mov_b32 v67, 0
    s_mov_b32 exec_lo, 0x11111111
    s_mov_b32 exec_hi, 0x11111111
    ds_write_b64 v1, v[64:65] offset:17664
    ds_write_b64 v1, v[66:67] offset:17728
    s_mov_b64 exec, -1
    v_mov_b32 v48, v40
    v_mov_b32 v49, v42
    s_nop 0
    v_max_f32_dpp v48, v48, v48 quad_perm:[1,0,3,2] row_mask:0xf bank_mask:0xf
    v_max_f32_dpp v49, v49, v49 quad_perm:[1,0,3,2] row_mask:0xf bank_mask:0xf
    s_nop 0
    v_max_f32_dpp v48, v48, v48 quad_perm:[2,3,0,1] row_mask:0xf bank_mask:0xf
    v_max_f32_dpp v49, v49, v49 quad_perm:[2,3,0,1] row_mask:0xf bank_mask:0xf
    s_nop 0
    v_max_f32_dpp v48, v48, v48 row_half_mirror row_mask:0xf bank_mask:0xf
    v_max_f32_dpp v49, v49, v49 row_half_mirror row_mask:0xf bank_mask:0xf
    s_nop 0
    v_max_f32_dpp v48, v48, v48 row_mirror row_mask:0xf bank_mask:0xf
    v_max_f32_dpp v49, v49, v49 row_mirror row_mask:0xf bank_mask:0xf
    v_sub_f32 v36, v40, v48
    v_sub_f32 v37, v42, v49
    v_exp_f32 v36, v36
    v_exp_f32 v37, v37
    s_nop 0
    s_nop 0
    v_add_f32_dpp v36, v36, v36 quad_perm:[1,0,3,2] row_mask:0xf bank_mask:0xf
    v_add_f32_dpp v37, v37, v37 quad_perm:[1,0,3,2] row_mask:0xf bank_mask:0xf
    s_nop 0
    v_add_f32_dpp v36, v36, v36 quad_perm:[2,3,0,1] row_mask:0xf bank_mask:0xf
    v_add_f32_dpp v37, v37, v37 quad_perm:[2,3,0,1] row_mask:0xf bank_mask:0xf
    s_nop 0
    v_add_f32_dpp v36, v36, v36 row_half_mirror row_mask:0xf bank_mask:0xf
    v_add_f32_dpp v37, v37, v37 row_half_mirror row_mask:0xf bank_mask:0xf
    s_nop 0
    v_add_f32_dpp v36, v36, v36 row_mirror row_mask:0xf bank_mask:0xf
    v_add_f32_dpp v37, v37, v37 row_mirror row_mask:0xf bank_mask:0xf
    v_log_f32 v36, v36
    v_log_f32 v37, v37
    v_mov_b32 v50, 2
    v_add_f32 v48, v48, v36
    v_add_f32 v49, v49, v37
    s_mov_b64 exec, 1
    ds_write_b64 v30, v[48:49] offset:17600
    s_waitcnt lgkmcnt(0)
    ds_write_b32 v30, v50 offset:17408
    s_waitcnt lgkmcnt(0)
    s_cmp_eq_u32 s2, 255
    s_cbranch_scc0 L_hdone
    s_mov_b64 exec, -1
    s_mov_b32 s59, 400000
    s_mov_b32 s44, 397312
L_ep:
    buffer_load_dword v32, v5, s[40:43], s44 offen offset:4 sc1
    buffer_load_dword v33, v5, s[40:43], s44 offen offset:1028 sc1
    buffer_load_dword v34, v5, s[40:43], s44 offen offset:2052 sc1
    buffer_load_dword v35, v5, s[40:43], s44 offen offset:3076 sc1
    s_waitcnt vmcnt(0)
    v_xor_b32 v32, s46, v32
    v_xor_b32 v33, s46, v33
    v_xor_b32 v34, s46, v34
    v_xor_b32 v35, s46, v35
    v_or3_b32 v32, v32, v33, v34
    v_or_b32 v32, v32, v35
    s_sub_u32 s59, s59, 1
    v_cmp_ne_u32 vcc, 0, v32
    s_cbranch_scc1 L_epx
    s_cbranch_vccnz L_ep
L_epx:
    s_mov_b64 exec, 1
    v_mov_b32 v32, s46
    buffer_store_dword v32, v30, s[40:43], 0 offen sc1
L_hdone:
L_end:
    s_endpgm
L_norm:
    s_mov_b32 s59, 3200000
L_f2w:
    ds_read_b32 v55, v6 offset:17408
    s_sub_u32 s59, s59, 1
    s_cbranch_scc1 L_f2wx
    s_waitcnt lgkmcnt(0)
    v_cmp_gt_u32 vcc, 2, v55
    s_cbranch_vccnz L_f2w
L_f2wx:
    ds_read_b32 v52, v204 offset:17600
    ds_read_b64 v[164:165], v198 offset:17664
    ds_read_b64 v[166:167], v198 offset:17696
    ds_read_b64 v[168:169], v198 offset:17728
    ds_read_b64 v[170:171], v198 offset:17760
    ds_read_b64 v[162:163], v199 offset:17536
    s_waitcnt lgkmcnt(0)
    v_sub_f32 v53, v29, v52
    v_exp_f32 v53, v53
    v_mov_b32 v29, v52
    v_mov_b32 v54, v53
    s_nop 1
    v_mov_b32_dpp v54, v53 row_ror:8 row_mask:0x3 bank_mask:0xc
    s_nop 1
    v_mov_b32_dpp v54, v53 row_ror:8 row_mask:0xc bank_mask:0x3
    v_mul_f32 v20, v20, v54
    v_mul_f32 v21, v21, v54
    v_mul_f32 v22, v22, v54
    v_mul_f32 v23, v23, v54
    v_mul_f32 v24, v24, v54
    v_mul_f32 v25, v25, v54
    v_mul_f32 v26, v26, v54
    v_mul_f32 v27, v27, v54
    s_branch L_normx
.fill 16, 4, 0xbf810000
.section .rodata,"a"
.p2align 6
.amdhsa_kernel gated_mix__gqa_block_cached__glu_gated_glu__decode_kernel
  .amdhsa_next_free_vgpr 212
  .amdhsa_next_free_sgpr 102
  .amdhsa_accum_offset 212
  .amdhsa_group_segment_fixed_size 0
  .amdhsa_kernarg_size 104
  .amdhsa_user_sgpr_count 2
  .amdhsa_user_sgpr_kernarg_segment_ptr 1
  .amdhsa_system_sgpr_workgroup_id_x 1
.end_amdhsa_kernel
```
